```python
import torch

def _softmax(x, axis=-1):
    return torch.softmax(x, dim=axis)
def _gelu(x):
    return torch.nn.functional.gelu(x, approximate="tanh")
def _silu(x):
    return torch.nn.functional.silu(x)
def _sigmoid(x):
    return torch.sigmoid(x)
def _layernorm(x, axis=-1, eps=1e-5):
    m = x.mean(dim=axis, keepdim=True)
    v = x.var(dim=axis, keepdim=True, unbiased=False)
    return (x - m) / torch.sqrt(v + eps)
def _scatter_add(tgt, idx, src, axis=0):
    return tgt.clone().index_add_(axis, idx, src)
def _segment_sum(src, seg, n):
    out = torch.zeros((n,) + src.shape[1:], dtype=src.dtype)
    return out.index_add_(0, seg, src)
def _pad(x, pw):
    flat = tuple(v for pair in reversed(pw) for v in pair)
    return torch.nn.functional.pad(x, flat)

kernel_name = 'sequential_preLN__ssm_conv_s4__glu_gated_reglu__prompt'

def setup_inputs():

    _w = (lambda a: (lambda t: t.to(torch.bfloat16) if t.is_floating_point() else t)(torch.as_tensor(a)))
    def _A_setup():
        B, L, D, N = 1, 2048, 448, 256
        A_re = -(lambda _x: torch.exp(torch.as_tensor(_x)))((lambda *s: torch.randn(*s, dtype=torch.bfloat16) * 3.2)(D, N))
        A_im = torch.pi * (lambda *s: torch.randn(*s, dtype=torch.bfloat16) * 0.05)(D, N)
        B_re = (lambda *s: torch.randn(*s, dtype=torch.bfloat16) * 0.05)(D, N)
        B_im = (lambda *s: torch.randn(*s, dtype=torch.bfloat16) * 0.05)(D, N)
        C_re = (lambda *s: torch.randn(*s, dtype=torch.bfloat16) * 0.05)(D, N)
        C_im = (lambda *s: torch.randn(*s, dtype=torch.bfloat16) * 0.05)(D, N)
        log_dt = (lambda *s: torch.randn(*s, dtype=torch.bfloat16) * 0.05)(D) * 0.5 - 4.0
        Dskip = (lambda *s: torch.randn(*s, dtype=torch.bfloat16) * 0.05)(D)
        return {
            "u": _w((lambda *s: torch.randn(*s, dtype=torch.bfloat16) * 0.05)(B, L, D)),
            "A_re": _w(A_re),
            "A_im": _w(A_im),
            "B_re": _w(B_re),
            "B_im": _w(B_im),
            "C_re": _w(C_re),
            "C_im": _w(C_im),
            "log_dt": _w(log_dt),
            "Dskip": _w(Dskip),
        }
    _A_in = _A_setup()

    def _B_setup():
        B, S, D, F = 1, 2048, 448, 1792
        return {
            "x": _w((lambda *s: torch.randn(*s, dtype=torch.bfloat16) * 0.05)(B, S, D)),
            "W_gate": _w((lambda *s: torch.randn(*s, dtype=torch.bfloat16) * 0.4)(D, F) * (2.0 / D) ** 0.5),
            "W_up": _w((lambda *s: torch.randn(*s, dtype=torch.bfloat16) * 0.4)(D, F) * (2.0 / D) ** 0.5),
            "W_down": _w((lambda *s: torch.randn(*s, dtype=torch.bfloat16) * 0.4)(F, D) * (1.0 / F) ** 0.5),
        }
    _B_in = _B_setup()

    return {
        "A_u": _A_in["u"],
        "A_A_re": _A_in["A_re"],
        "A_A_im": _A_in["A_im"],
        "A_B_re": _A_in["B_re"],
        "A_B_im": _A_in["B_im"],
        "A_C_re": _A_in["C_re"],
        "A_C_im": _A_in["C_im"],
        "A_log_dt": _A_in["log_dt"],
        "A_Dskip": _A_in["Dskip"],
        "B_x": _B_in["x"],
        "B_W_gate": _B_in["W_gate"],
        "B_W_up": _B_in["W_up"],
        "B_W_down": _B_in["W_down"],
    }

def reference(A_u, A_A_re, A_A_im, A_B_re, A_B_im, A_C_re, A_C_im, A_log_dt, A_Dskip, B_x, B_W_gate, B_W_up, B_W_down):
    def _A_ref(u, A_re, A_im, B_re, B_im, C_re, C_im, log_dt, Dskip):
        Bsz, L, D = u.shape
        dt = torch.exp(log_dt)[:, None]
        A = A_re + 1j * A_im
        Bc = B_re + 1j * B_im
        Cc = C_re + 1j * C_im
        logdA = dt * A
        dB = dt * Bc
        l = (lambda x, dt: x.to(dt))(torch.arange(L), A_re.dtype)
        P = torch.exp(logdA[:, :, None] * l[None, None, :])
        K = torch.einsum("dn,dnl,dn->dl", Cc, P, dB).real
        L2 = 2 * L
        Kp = _pad(K, ((0, 0), (0, L)))
        up = (lambda x, *d: x.permute(*d))(u, 0, 2, 1)
        up = _pad(up, ((0, 0), (0, 0), (0, L)))
        Kf = (lambda x, axes=(-2,-1): torch.fft.rfft2(x.float(), dim=axes))(Kp[:, None, :], axes=(-2, -1))
        Uf = (lambda x, axes=(-2,-1): torch.fft.rfft2(x.float(), dim=axes))(up[:, :, None, :], axes=(-2, -1))
        Yf = Uf * Kf[None, :, :, :]
        y = (lambda x, s, axes=(-2,-1): torch.fft.irfft2(x, s=s, dim=axes).to(torch.bfloat16))(Yf, (1, L2), axes=(-2, -1))[:, :, 0, :L]
        y = (lambda x, *d: x.permute(*d))(y, 0, 2, 1) + u * Dskip[None, None, :]
        return y

    def _B_ref(x, W_gate, W_up, W_down):
        gate = torch.einsum("bsd,df->bsf", x, W_gate)
        up = torch.einsum("bsd,df->bsf", x, W_up)
        gate = gate * (lambda x, dt: x.to(dt))(gate > 0, gate.dtype)
        h = gate * up
        return torch.einsum("bsf,fd->bsd", h, W_down)

    x = A_u
    h = x + _A_ref(_layernorm(x, axis=-1), A_A_re, A_A_im, A_B_re, A_B_im, A_C_re, A_C_im, A_log_dt, A_Dskip)
    h2 = h + _B_ref(_layernorm(h, axis=-1), B_W_gate, B_W_up, B_W_down)
    return h2
```

```asm
; @launch grid=(256,1,1) block=(512,1,1) lds=158208
.amdgcn_target "amdgcn-amd-amdhsa--gfx950"
.text
.globl sequential_preLN__ssm_conv_s4__glu_gated_reglu__prompt_kernel
.p2align 8
.type sequential_preLN__ssm_conv_s4__glu_gated_reglu__prompt_kernel,@function
sequential_preLN__ssm_conv_s4__glu_gated_reglu__prompt_kernel:
    s_cmp_ge_u32 s2, 256
    s_cbranch_scc1 EXIT
    s_load_dwordx16 s[4:19], s[0:1], 8
    s_load_dwordx2 s[44:45], s[0:1], 0
    s_load_dwordx8 s[48:55], s[0:1], 80
    s_load_dwordx4 s[64:67], s[0:1], 112
    s_getpc_b64 s[58:59]
PC0:
    s_lshr_b32 s22, s2, 3
    s_mul_i32 s22, s22, 1664
    v_subrev_u32 v1, 448, v0
    v_cmp_gt_u32 vcc, 13, v1
    v_lshl_add_u32 v1, v1, 7, s22
    v_min_u32 v1, TABLE_END-PC0-4, v1
    s_and_saveexec_b64 s[24:25], vcc
    s_cbranch_execz PF_skip
    global_load_dword v127, v1, s[58:59]
PF_skip:
    s_mov_b64 exec, s[24:25]
    v_lshrrev_b32 v1, 6, v0
    v_and_b32 v2, 63, v0
    s_nop 0
    v_readfirstlane_b32 s22, v1
    s_waitcnt lgkmcnt(0)
    s_and_b32 s23, s22, 3
    s_mov_b32 s20, s66
    s_mov_b32 s21, s67
    s_mov_b32 s60, s66
    s_mov_b32 s61, s67
    s_mov_b32 s62, 0x1800000
    s_mov_b32 s63, 0x00020000
    s_lshl_b32 s26, s2, 3
    s_add_u32 s26, s26, s22
    s_mul_i32 s26, s26, 896
    v_lshl_add_u32 v1, v2, 4, s26
    v_mov_b32 v96, 0
    v_mov_b32 v97, 0
    v_mov_b32 v98, 0
    v_mov_b32 v99, 0
    s_mov_b32 s32, -1
    s_mov_b32 s33, 0x00ffffff
    s_mov_b64 exec, s[32:33]
    global_load_dwordx4 v[96:99], v1, s[44:45]
    s_mov_b64 exec, 1
    buffer_load_dword v126, off, s[60:63], 0 sc1
    s_mov_b64 exec, -1
    s_cmp_lt_u32 s2, 32
    s_cbranch_scc1 AUX
    s_sub_u32 s3, s2, 32
    s_and_b32 s26, s3, 7
    s_mul_i32 s26, s26, 28
    s_lshr_b32 s27, s3, 3
    s_add_u32 s43, s26, s27
    s_lshl_b32 s27, s43, 10
    v_lshl_add_u32 v3, v0, 1, s27
    s_lshr_b32 s28, s22, 2
    s_lshl_b32 s26, s43, 1
    s_add_u32 s26, s26, s28
    s_lshl_b32 s26, s26, 1
    v_mov_b32 v31, s26
    global_load_ushort v10, v31, s[16:17]
    global_load_ushort v4, v3, s[4:5]
    global_load_ushort v5, v3, s[6:7]
    global_load_ushort v6, v3, s[8:9]
    global_load_ushort v7, v3, s[10:11]
    global_load_ushort v8, v3, s[12:13]
    global_load_ushort v9, v3, s[14:15]
    global_load_ushort v29, v31, s[18:19]
    s_mul_i32 s31, s28, 60192
    s_lshl_b32 s26, s23, 8
    s_add_u32 m0, s31, s26
    v_mov_b32 v30, 0x00003f80
    ds_write_addtid_b32 v30
    s_and_b32 s24, s3, 3
    s_lshl_b32 s24, s24, 2
    s_bfe_u32 s25, s3, 0x20003
    s_add_u32 s24, s24, s25
    s_bfe_u32 s46, s3, 0x10002
    s_mul_i32 s25, s46, 7
    s_lshr_b32 s47, s3, 5
    s_add_u32 s25, s25, s47
    s_mov_b32 s26, 0x3f803f80
    v_mov_b32 v104, 0
    v_mov_b32 v105, 0
    s_mul_i32 s27, s22, 928
    s_add_u32 s27, s27, 122880
    v_lshl_add_u32 v116, v2, 4, s27
    v_bfe_u32 v117, v2, 2, 2
    v_mul_u32_u24 v117, 928, v117
    v_and_b32 v118, 3, v2
    v_lshl_add_u32 v117, v118, 3, v117
    v_lshrrev_b32 v118, 4, v2
    v_lshl_add_u32 v117, v118, 5, v117
    s_min_u32 s34, s22, 6
    s_lshl_b32 s27, s34, 7
    s_add_u32 s27, s27, 122880
    v_add_u32 v117, s27, v117
    v_lshrrev_b32 v118, 3, v2
    v_mul_u32_u24 v118, 33024, v118
    v_and_b32 v119, 7, v2
    v_lshl_add_u32 v118, v119, 4, v118
    s_mul_i32 s34, s34, 264192
    s_lshl_b32 s35, s2, 7
    s_add_u32 s34, s34, s35
    s_add_u32 s34, s34, 0x800000
    s_lshl_b32 s35, s2, 6
    s_add_u32 s35, s35, 0x4000
    s_lshl_b32 s27, s22, 2
    s_add_u32 s27, s27, 130560
    v_lshl_add_u32 v119, v2, 5, s27
    v_lshlrev_b32 v115, 4, v2
    s_waitcnt vmcnt(9)
    s_mov_b64 exec, s[32:33]
    ds_write_b128 v116, v[96:99]
    s_mov_b64 exec, -1
    v_dot2c_f32_bf16 v104, s26, v96
    v_dot2c_f32_bf16 v105, v96, v96
    v_dot2c_f32_bf16 v104, s26, v97
    v_dot2c_f32_bf16 v105, v97, v97
    v_dot2c_f32_bf16 v104, s26, v98
    v_dot2c_f32_bf16 v105, v98, v98
    v_dot2c_f32_bf16 v104, s26, v99
    v_dot2c_f32_bf16 v105, v99, v99
    s_waitcnt lgkmcnt(0)
    s_barrier
    ds_read_b64_tr_b16 v[100:101], v117
    ds_read_b64_tr_b16 v[102:103], v117 offset:3712
    s_nop 0
    v_add_f32_dpp v104, v104, v104 quad_perm:[1,0,3,2] row_mask:0xf bank_mask:0xf
    v_add_f32_dpp v105, v105, v105 quad_perm:[1,0,3,2] row_mask:0xf bank_mask:0xf
    s_nop 0
    v_add_f32_dpp v104, v104, v104 quad_perm:[2,3,0,1] row_mask:0xf bank_mask:0xf
    v_add_f32_dpp v105, v105, v105 quad_perm:[2,3,0,1] row_mask:0xf bank_mask:0xf
    s_nop 0
    v_add_f32_dpp v104, v104, v104 row_half_mirror row_mask:0xf bank_mask:0xf
    v_add_f32_dpp v105, v105, v105 row_half_mirror row_mask:0xf bank_mask:0xf
    s_nop 0
    v_add_f32_dpp v104, v104, v104 row_mirror row_mask:0xf bank_mask:0xf
    v_add_f32_dpp v105, v105, v105 row_mirror row_mask:0xf bank_mask:0xf
    s_waitcnt lgkmcnt(0)
    s_cmp_eq_u32 s22, 7
    s_cbranch_scc1 P0_a1
    buffer_store_dwordx4 v[100:103], v118, s[60:63], s34 offen sc1
    P0_a1:
    v_mov_b32 v120, v104
    v_mov_b32 v121, v105
    s_nop 1
    v_permlane16_swap_b32 v104, v120
    v_permlane16_swap_b32 v105, v121
    v_add_f32 v104, v104, v120
    v_add_f32 v105, v105, v121
    v_mov_b32 v120, v104
    v_mov_b32 v121, v105
    s_nop 1
    v_permlane32_swap_b32 v104, v120
    v_permlane32_swap_b32 v105, v121
    v_add_f32 v104, v104, v120
    v_add_f32 v105, v105, v121
    v_mul_f32 v104, 0x3b124925, v104
    v_mul_f32 v105, 0x3b124925, v105
    v_fma_f32 v105, -v104, v104, v105
    v_cvt_pk_bf16_f32 v120, v104, v104
    v_lshlrev_b32 v120, 16, v120
    v_max_f32 v105, 0, v105
    v_cvt_pk_bf16_f32 v105, v105, v105
    v_lshlrev_b32 v105, 16, v105
    v_add_f32 v105, 0x3727c5ac, v105
    v_cvt_pk_bf16_f32 v105, v105, v105
    v_lshlrev_b32 v105, 16, v105
    v_sqrt_f32 v105, v105
    s_nop 0
    v_cvt_pk_bf16_f32 v105, v105, v105
    v_lshlrev_b32 v105, 16, v105
    v_rcp_f32 v121, v105
    v_cmp_eq_u32 vcc, 0, v2
    s_mov_b64 exec, 3
    s_nop 0
    v_cndmask_b32 v120, v121, v120, vcc
    ds_write_b32 v119, v120
    s_mov_b64 exec, -1
    s_waitcnt lgkmcnt(0)
    s_barrier
    s_cmp_lg_u32 s22, 7
    s_cbranch_scc1 P0_b1
    s_mov_b64 exec, 15
    v_add_u32 v114, 130560, v115
    ds_read_b128 v[100:103], v114
    s_waitcnt lgkmcnt(0)
    buffer_store_dwordx4 v[100:103], v115, s[60:63], s35 offen sc1
    s_mov_b64 exec, -1
P0_b1:
    s_add_u32 s58, s58, KG_TABLE-PC0
    s_addc_u32 s59, s59, 0
    v_lshlrev_b32 v18, 4, v0
    v_add_u32 v19, 8192, v18
    v_add_u32 v17, 16384, v18
    global_load_dwordx4 v[12:15], v17, s[58:59]
    global_load_dwordx4 v[20:23], v18, s[58:59]
    global_load_dwordx4 v[24:27], v19, s[58:59]
    s_waitcnt vmcnt(9)
    v_lshlrev_b32 v28, 16, v10
    v_mul_f32 v28, 0x3fb8aa3b, v28
    v_exp_f32 v28, v28
    v_lshlrev_b32 v44, 16, v4
    v_cvt_pk_bf16_f32 v28, v28, v28
    v_lshlrev_b32 v45, 16, v5
    v_lshlrev_b32 v28, 16, v28
    v_mul_f32 v50, v28, v44
    v_mul_f32 v51, v28, v45
    v_mul_f32 v50, 0x3fb8aa3b, v50
    v_mul_f32 v51, 0.15915494, v51
    v_mul_f32 v88, 0x41000000, v50
    v_mul_f32 v89, 0x41000000, v51
    v_mul_f32 v90, 0x43000000, v50
    v_mul_f32 v91, 0x43000000, v51
    v_exp_f32 v86, v50
    v_fract_f32 v87, v51
    v_exp_f32 v88, v88
    v_fract_f32 v89, v89
    v_exp_f32 v90, v90
    v_fract_f32 v91, v91
    v_cos_f32 v56, v87
    v_sin_f32 v57, v87
    v_cos_f32 v70, v89
    v_sin_f32 v71, v89
    v_cos_f32 v72, v91
    v_sin_f32 v73, v91
    v_pk_mul_f32 v[56:57], v[56:57], v[86:87] op_sel_hi:[1,0]
    v_pk_mul_f32 v[70:71], v[70:71], v[88:89] op_sel_hi:[1,0]
    v_pk_mul_f32 v[72:73], v[72:73], v[90:91] op_sel_hi:[1,0]
    v_cvt_pk_bf16_f32 v92, v56, v57
    ds_write_addtid_b32 v92 offset:1056
    v_pk_mul_f32 v[52:53], v[56:57], v[56:57] op_sel:[0,0] op_sel_hi:[1,0]
    v_pk_fma_f32 v[58:59], v[56:57], v[56:57], v[52:53] op_sel:[1,1,0] op_sel_hi:[0,1,1] neg_lo:[1,0,0]
    v_cvt_pk_bf16_f32 v93, v58, v59
    ds_write_addtid_b32 v93 offset:2112
    v_pk_mul_f32 v[52:53], v[58:59], v[56:57] op_sel:[0,0] op_sel_hi:[1,0]
    v_pk_fma_f32 v[60:61], v[58:59], v[56:57], v[52:53] op_sel:[1,1,0] op_sel_hi:[0,1,1] neg_lo:[1,0,0]
    v_cvt_pk_bf16_f32 v92, v60, v61
    ds_write_addtid_b32 v92 offset:3168
    v_pk_mul_f32 v[52:53], v[58:59], v[58:59] op_sel:[0,0] op_sel_hi:[1,0]
    v_pk_fma_f32 v[62:63], v[58:59], v[58:59], v[52:53] op_sel:[1,1,0] op_sel_hi:[0,1,1] neg_lo:[1,0,0]
    v_cvt_pk_bf16_f32 v93, v62, v63
    ds_write_addtid_b32 v93 offset:4224
    v_pk_mul_f32 v[52:53], v[62:63], v[56:57] op_sel:[0,0] op_sel_hi:[1,0]
    v_pk_fma_f32 v[64:65], v[62:63], v[56:57], v[52:53] op_sel:[1,1,0] op_sel_hi:[0,1,1] neg_lo:[1,0,0]
    v_cvt_pk_bf16_f32 v92, v64, v65
    ds_write_addtid_b32 v92 offset:5280
    v_pk_mul_f32 v[52:53], v[62:63], v[58:59] op_sel:[0,0] op_sel_hi:[1,0]
    v_pk_fma_f32 v[66:67], v[62:63], v[58:59], v[52:53] op_sel:[1,1,0] op_sel_hi:[0,1,1] neg_lo:[1,0,0]
    v_cvt_pk_bf16_f32 v93, v66, v67
    ds_write_addtid_b32 v93 offset:6336
    v_pk_mul_f32 v[52:53], v[62:63], v[60:61] op_sel:[0,0] op_sel_hi:[1,0]
    v_pk_fma_f32 v[68:69], v[62:63], v[60:61], v[52:53] op_sel:[1,1,0] op_sel_hi:[0,1,1] neg_lo:[1,0,0]
    v_cvt_pk_bf16_f32 v92, v68, v69
    ds_write_addtid_b32 v92 offset:7392
    v_cvt_pk_bf16_f32 v93, v72, v73
    ds_write_addtid_b32 v93 offset:8448
    v_pk_mul_f32 v[52:53], v[72:73], v[56:57] op_sel:[0,0] op_sel_hi:[1,0]
    v_pk_fma_f32 v[82:83], v[72:73], v[56:57], v[52:53] op_sel:[1,1,0] op_sel_hi:[0,1,1] neg_lo:[1,0,0]
    v_cvt_pk_bf16_f32 v92, v82, v83
    ds_write_addtid_b32 v92 offset:9504
    v_pk_mul_f32 v[52:53], v[72:73], v[58:59] op_sel:[0,0] op_sel_hi:[1,0]
    v_pk_fma_f32 v[82:83], v[72:73], v[58:59], v[52:53] op_sel:[1,1,0] op_sel_hi:[0,1,1] neg_lo:[1,0,0]
    v_cvt_pk_bf16_f32 v93, v82, v83
    ds_write_addtid_b32 v93 offset:10560
    v_pk_mul_f32 v[52:53], v[72:73], v[60:61] op_sel:[0,0] op_sel_hi:[1,0]
    v_pk_fma_f32 v[82:83], v[72:73], v[60:61], v[52:53] op_sel:[1,1,0] op_sel_hi:[0,1,1] neg_lo:[1,0,0]
    v_cvt_pk_bf16_f32 v92, v82, v83
    ds_write_addtid_b32 v92 offset:11616
    v_pk_mul_f32 v[52:53], v[72:73], v[62:63] op_sel:[0,0] op_sel_hi:[1,0]
    v_pk_fma_f32 v[82:83], v[72:73], v[62:63], v[52:53] op_sel:[1,1,0] op_sel_hi:[0,1,1] neg_lo:[1,0,0]
    v_cvt_pk_bf16_f32 v93, v82, v83
    ds_write_addtid_b32 v93 offset:12672
    v_pk_mul_f32 v[52:53], v[72:73], v[64:65] op_sel:[0,0] op_sel_hi:[1,0]
    v_pk_fma_f32 v[82:83], v[72:73], v[64:65], v[52:53] op_sel:[1,1,0] op_sel_hi:[0,1,1] neg_lo:[1,0,0]
    v_cvt_pk_bf16_f32 v92, v82, v83
    ds_write_addtid_b32 v92 offset:13728
    v_pk_mul_f32 v[52:53], v[72:73], v[66:67] op_sel:[0,0] op_sel_hi:[1,0]
    v_pk_fma_f32 v[82:83], v[72:73], v[66:67], v[52:53] op_sel:[1,1,0] op_sel_hi:[0,1,1] neg_lo:[1,0,0]
    v_cvt_pk_bf16_f32 v93, v82, v83
    ds_write_addtid_b32 v93 offset:14784
    v_pk_mul_f32 v[52:53], v[72:73], v[68:69] op_sel:[0,0] op_sel_hi:[1,0]
    v_pk_fma_f32 v[82:83], v[72:73], v[68:69], v[52:53] op_sel:[1,1,0] op_sel_hi:[0,1,1] neg_lo:[1,0,0]
    v_cvt_pk_bf16_f32 v92, v82, v83
    ds_write_addtid_b32 v92 offset:15840
    v_pk_mul_f32 v[52:53], v[72:73], v[72:73] op_sel:[0,0] op_sel_hi:[1,0]
    v_pk_fma_f32 v[74:75], v[72:73], v[72:73], v[52:53] op_sel:[1,1,0] op_sel_hi:[0,1,1] neg_lo:[1,0,0]
    s_waitcnt vmcnt(3)
    v_readfirstlane_b32 s41, v126
    s_barrier
    s_mul_i32 s42, s41, 0x9e3779b1
    s_add_u32 s42, s42, 0x7f4a7c15
    s_cmp_lg_u32 s22, 0
    s_cbranch_scc1 P1_f1
    s_lshr_b32 s28, s2, 2
    s_lshl_b32 s28, s28, 7
    s_and_b32 s32, s2, 3
    s_lshl_b32 s32, s32, 2
    s_add_u32 s28, s28, s32
    s_add_u32 s28, s28, 0x40000
    v_mul_u32_u24 v1, 8320, v2
    v_mov_b32 v3, s42
    s_mov_b64 exec, 15
    buffer_store_dword v3, v1, s[60:63], s28 offen sc1
    s_mov_b64 exec, -1
P1_f1:
    v_cvt_pk_bf16_f32 v93, v74, v75
    ds_write_addtid_b32 v93 offset:50688
    v_pk_mul_f32 v[52:53], v[74:75], v[58:59] op_sel:[0,0] op_sel_hi:[1,0]
    v_pk_fma_f32 v[82:83], v[74:75], v[58:59], v[52:53] op_sel:[1,1,0] op_sel_hi:[0,1,1] neg_lo:[1,0,0]
    v_cvt_pk_bf16_f32 v92, v82, v83
    ds_write_addtid_b32 v92 offset:51744
    v_pk_mul_f32 v[52:53], v[74:75], v[62:63] op_sel:[0,0] op_sel_hi:[1,0]
    v_pk_fma_f32 v[82:83], v[74:75], v[62:63], v[52:53] op_sel:[1,1,0] op_sel_hi:[0,1,1] neg_lo:[1,0,0]
    v_cvt_pk_bf16_f32 v93, v82, v83
    ds_write_addtid_b32 v93 offset:52800
    v_pk_mul_f32 v[52:53], v[74:75], v[66:67] op_sel:[0,0] op_sel_hi:[1,0]
    v_pk_fma_f32 v[82:83], v[74:75], v[66:67], v[52:53] op_sel:[1,1,0] op_sel_hi:[0,1,1] neg_lo:[1,0,0]
    v_cvt_pk_bf16_f32 v92, v82, v83
    ds_write_addtid_b32 v92 offset:53856
    v_pk_mul_f32 v[52:53], v[74:75], v[72:73] op_sel:[0,0] op_sel_hi:[1,0]
    v_pk_fma_f32 v[76:77], v[74:75], v[72:73], v[52:53] op_sel:[1,1,0] op_sel_hi:[0,1,1] neg_lo:[1,0,0]
    v_cvt_pk_bf16_f32 v93, v76, v77
    ds_write_addtid_b32 v93 offset:54912
    v_pk_mul_f32 v[52:53], v[76:77], v[58:59] op_sel:[0,0] op_sel_hi:[1,0]
    v_pk_fma_f32 v[82:83], v[76:77], v[58:59], v[52:53] op_sel:[1,1,0] op_sel_hi:[0,1,1] neg_lo:[1,0,0]
    v_cvt_pk_bf16_f32 v92, v82, v83
    ds_write_addtid_b32 v92 offset:55968
    v_pk_mul_f32 v[52:53], v[76:77], v[62:63] op_sel:[0,0] op_sel_hi:[1,0]
    v_pk_fma_f32 v[82:83], v[76:77], v[62:63], v[52:53] op_sel:[1,1,0] op_sel_hi:[0,1,1] neg_lo:[1,0,0]
    v_cvt_pk_bf16_f32 v93, v82, v83
    ds_write_addtid_b32 v93 offset:57024
    v_pk_mul_f32 v[52:53], v[76:77], v[66:67] op_sel:[0,0] op_sel_hi:[1,0]
    v_pk_fma_f32 v[82:83], v[76:77], v[66:67], v[52:53] op_sel:[1,1,0] op_sel_hi:[0,1,1] neg_lo:[1,0,0]
    v_cvt_pk_bf16_f32 v92, v82, v83
    ds_write_addtid_b32 v92 offset:58080
    v_pk_mul_f32 v[52:53], v[76:77], v[72:73] op_sel:[0,0] op_sel_hi:[1,0]
    v_pk_fma_f32 v[74:75], v[76:77], v[72:73], v[52:53] op_sel:[1,1,0] op_sel_hi:[0,1,1] neg_lo:[1,0,0]
    v_cvt_pk_bf16_f32 v93, v74, v75
    ds_write_addtid_b32 v93 offset:16896
    v_pk_mul_f32 v[52:53], v[74:75], v[62:63] op_sel:[0,0] op_sel_hi:[1,0]
    v_pk_fma_f32 v[82:83], v[74:75], v[62:63], v[52:53] op_sel:[1,1,0] op_sel_hi:[0,1,1] neg_lo:[1,0,0]
    v_cvt_pk_bf16_f32 v92, v82, v83
    ds_write_addtid_b32 v92 offset:21120
    v_pk_mul_f32 v[52:53], v[74:75], v[72:73] op_sel:[0,0] op_sel_hi:[1,0]
    v_pk_fma_f32 v[76:77], v[74:75], v[72:73], v[52:53] op_sel:[1,1,0] op_sel_hi:[0,1,1] neg_lo:[1,0,0]
    v_cvt_pk_bf16_f32 v93, v76, v77
    ds_write_addtid_b32 v93 offset:17952
    v_pk_mul_f32 v[52:53], v[76:77], v[62:63] op_sel:[0,0] op_sel_hi:[1,0]
    v_pk_fma_f32 v[82:83], v[76:77], v[62:63], v[52:53] op_sel:[1,1,0] op_sel_hi:[0,1,1] neg_lo:[1,0,0]
    v_cvt_pk_bf16_f32 v92, v82, v83
    ds_write_addtid_b32 v92 offset:22176
    v_pk_mul_f32 v[52:53], v[76:77], v[72:73] op_sel:[0,0] op_sel_hi:[1,0]
    v_pk_fma_f32 v[74:75], v[76:77], v[72:73], v[52:53] op_sel:[1,1,0] op_sel_hi:[0,1,1] neg_lo:[1,0,0]
    v_cvt_pk_bf16_f32 v93, v74, v75
    ds_write_addtid_b32 v93 offset:19008
    v_pk_mul_f32 v[52:53], v[74:75], v[62:63] op_sel:[0,0] op_sel_hi:[1,0]
    v_pk_fma_f32 v[82:83], v[74:75], v[62:63], v[52:53] op_sel:[1,1,0] op_sel_hi:[0,1,1] neg_lo:[1,0,0]
    v_cvt_pk_bf16_f32 v92, v82, v83
    ds_write_addtid_b32 v92 offset:23232
    v_pk_mul_f32 v[52:53], v[74:75], v[72:73] op_sel:[0,0] op_sel_hi:[1,0]
    v_pk_fma_f32 v[76:77], v[74:75], v[72:73], v[52:53] op_sel:[1,1,0] op_sel_hi:[0,1,1] neg_lo:[1,0,0]
    v_cvt_pk_bf16_f32 v93, v76, v77
    ds_write_addtid_b32 v93 offset:20064
    v_pk_mul_f32 v[52:53], v[76:77], v[62:63] op_sel:[0,0] op_sel_hi:[1,0]
    v_pk_fma_f32 v[82:83], v[76:77], v[62:63], v[52:53] op_sel:[1,1,0] op_sel_hi:[0,1,1] neg_lo:[1,0,0]
    v_cvt_pk_bf16_f32 v92, v82, v83
    ds_write_addtid_b32 v92 offset:24288
    v_pk_mul_f32 v[52:53], v[76:77], v[72:73] op_sel:[0,0] op_sel_hi:[1,0]
    v_pk_fma_f32 v[74:75], v[76:77], v[72:73], v[52:53] op_sel:[1,1,0] op_sel_hi:[0,1,1] neg_lo:[1,0,0]
    v_cvt_pk_bf16_f32 v93, v74, v75
    ds_write_addtid_b32 v93 offset:25344
    v_pk_mul_f32 v[52:53], v[74:75], v[72:73] op_sel:[0,0] op_sel_hi:[1,0]
    v_pk_fma_f32 v[76:77], v[74:75], v[72:73], v[52:53] op_sel:[1,1,0] op_sel_hi:[0,1,1] neg_lo:[1,0,0]
    v_cvt_pk_bf16_f32 v92, v76, v77
    ds_write_addtid_b32 v92 offset:26400
    v_pk_mul_f32 v[52:53], v[76:77], v[72:73] op_sel:[0,0] op_sel_hi:[1,0]
    v_pk_fma_f32 v[74:75], v[76:77], v[72:73], v[52:53] op_sel:[1,1,0] op_sel_hi:[0,1,1] neg_lo:[1,0,0]
    v_cvt_pk_bf16_f32 v93, v74, v75
    ds_write_addtid_b32 v93 offset:27456
    v_pk_mul_f32 v[52:53], v[74:75], v[72:73] op_sel:[0,0] op_sel_hi:[1,0]
    v_pk_fma_f32 v[76:77], v[74:75], v[72:73], v[52:53] op_sel:[1,1,0] op_sel_hi:[0,1,1] neg_lo:[1,0,0]
    v_cvt_pk_bf16_f32 v92, v76, v77
    ds_write_addtid_b32 v92 offset:28512
    v_pk_mul_f32 v[52:53], v[76:77], v[72:73] op_sel:[0,0] op_sel_hi:[1,0]
    v_pk_fma_f32 v[74:75], v[76:77], v[72:73], v[52:53] op_sel:[1,1,0] op_sel_hi:[0,1,1] neg_lo:[1,0,0]
    v_cvt_pk_bf16_f32 v93, v74, v75
    ds_write_addtid_b32 v93 offset:29568
    v_pk_mul_f32 v[52:53], v[74:75], v[72:73] op_sel:[0,0] op_sel_hi:[1,0]
    v_pk_fma_f32 v[76:77], v[74:75], v[72:73], v[52:53] op_sel:[1,1,0] op_sel_hi:[0,1,1] neg_lo:[1,0,0]
    v_cvt_pk_bf16_f32 v92, v76, v77
    ds_write_addtid_b32 v92 offset:30624
    v_pk_mul_f32 v[52:53], v[76:77], v[72:73] op_sel:[0,0] op_sel_hi:[1,0]
    v_pk_fma_f32 v[74:75], v[76:77], v[72:73], v[52:53] op_sel:[1,1,0] op_sel_hi:[0,1,1] neg_lo:[1,0,0]
    v_cvt_pk_bf16_f32 v93, v74, v75
    ds_write_addtid_b32 v93 offset:31680
    v_pk_mul_f32 v[52:53], v[74:75], v[72:73] op_sel:[0,0] op_sel_hi:[1,0]
    v_pk_fma_f32 v[76:77], v[74:75], v[72:73], v[52:53] op_sel:[1,1,0] op_sel_hi:[0,1,1] neg_lo:[1,0,0]
    v_cvt_pk_bf16_f32 v92, v76, v77
    ds_write_addtid_b32 v92 offset:32736
    v_pk_mul_f32 v[52:53], v[76:77], v[72:73] op_sel:[0,0] op_sel_hi:[1,0]
    v_pk_fma_f32 v[74:75], v[76:77], v[72:73], v[52:53] op_sel:[1,1,0] op_sel_hi:[0,1,1] neg_lo:[1,0,0]
    v_cvt_pk_bf16_f32 v93, v74, v75
    ds_write_addtid_b32 v93 offset:59136
    s_lshr_b32 s28, s22, 2
    v_lshlrev_b32 v46, 16, v6
    v_lshlrev_b32 v47, 16, v7
    v_lshlrev_b32 v48, 16, v8
    v_lshlrev_b32 v49, 16, v9
    v_lshlrev_b32 v29, 16, v29
    v_and_b32 v4, 255, v0
    v_cmp_eq_u32 vcc, 0, v4
    v_pk_mul_f32 v[52:53], v[48:49], v[46:47] op_sel:[0,0] op_sel_hi:[1,0]
    v_pk_fma_f32 v[78:79], v[48:49], v[46:47], v[52:53] op_sel:[1,1,0] op_sel_hi:[0,1,1] neg_lo:[1,0,0]
    v_cndmask_b32 v29, 0, v29, vcc
    v_pk_mul_f32 v[78:79], v[78:79], v[28:29] op_sel_hi:[1,0]
    v_cvt_pk_bf16_f32 v92, v78, -v79
    ds_write_addtid_b32 v92 offset:33792
    v_pk_mul_f32 v[54:55], v[78:79], v[70:71] op_sel:[0,0] op_sel_hi:[1,0]
    v_pk_fma_f32 v[80:81], v[78:79], v[70:71], v[54:55] op_sel:[1,1,0] op_sel_hi:[0,1,1] neg_lo:[1,0,0]
    v_cvt_pk_bf16_f32 v93, v80, -v81
    ds_write_addtid_b32 v93 offset:34848
    v_pk_mul_f32 v[54:55], v[80:81], v[70:71] op_sel:[0,0] op_sel_hi:[1,0]
    v_pk_fma_f32 v[78:79], v[80:81], v[70:71], v[54:55] op_sel:[1,1,0] op_sel_hi:[0,1,1] neg_lo:[1,0,0]
    v_cvt_pk_bf16_f32 v92, v78, -v79
    ds_write_addtid_b32 v92 offset:35904
    v_pk_mul_f32 v[54:55], v[78:79], v[70:71] op_sel:[0,0] op_sel_hi:[1,0]
    v_pk_fma_f32 v[80:81], v[78:79], v[70:71], v[54:55] op_sel:[1,1,0] op_sel_hi:[0,1,1] neg_lo:[1,0,0]
    v_cvt_pk_bf16_f32 v93, v80, -v81
    ds_write_addtid_b32 v93 offset:36960
    v_pk_mul_f32 v[54:55], v[80:81], v[70:71] op_sel:[0,0] op_sel_hi:[1,0]
    v_pk_fma_f32 v[78:79], v[80:81], v[70:71], v[54:55] op_sel:[1,1,0] op_sel_hi:[0,1,1] neg_lo:[1,0,0]
    v_cvt_pk_bf16_f32 v92, v78, -v79
    ds_write_addtid_b32 v92 offset:38016
    v_pk_mul_f32 v[54:55], v[78:79], v[70:71] op_sel:[0,0] op_sel_hi:[1,0]
    v_pk_fma_f32 v[80:81], v[78:79], v[70:71], v[54:55] op_sel:[1,1,0] op_sel_hi:[0,1,1] neg_lo:[1,0,0]
    v_cvt_pk_bf16_f32 v93, v80, -v81
    ds_write_addtid_b32 v93 offset:39072
    v_pk_mul_f32 v[54:55], v[80:81], v[70:71] op_sel:[0,0] op_sel_hi:[1,0]
    v_pk_fma_f32 v[78:79], v[80:81], v[70:71], v[54:55] op_sel:[1,1,0] op_sel_hi:[0,1,1] neg_lo:[1,0,0]
    v_cvt_pk_bf16_f32 v92, v78, -v79
    ds_write_addtid_b32 v92 offset:40128
    v_pk_mul_f32 v[54:55], v[78:79], v[70:71] op_sel:[0,0] op_sel_hi:[1,0]
    v_pk_fma_f32 v[80:81], v[78:79], v[70:71], v[54:55] op_sel:[1,1,0] op_sel_hi:[0,1,1] neg_lo:[1,0,0]
    v_cvt_pk_bf16_f32 v93, v80, -v81
    ds_write_addtid_b32 v93 offset:41184
    v_pk_mul_f32 v[54:55], v[80:81], v[70:71] op_sel:[0,0] op_sel_hi:[1,0]
    v_pk_fma_f32 v[78:79], v[80:81], v[70:71], v[54:55] op_sel:[1,1,0] op_sel_hi:[0,1,1] neg_lo:[1,0,0]
    v_cvt_pk_bf16_f32 v92, v78, -v79
    ds_write_addtid_b32 v92 offset:42240
    v_pk_mul_f32 v[54:55], v[78:79], v[70:71] op_sel:[0,0] op_sel_hi:[1,0]
    v_pk_fma_f32 v[80:81], v[78:79], v[70:71], v[54:55] op_sel:[1,1,0] op_sel_hi:[0,1,1] neg_lo:[1,0,0]
    v_cvt_pk_bf16_f32 v93, v80, -v81
    ds_write_addtid_b32 v93 offset:43296
    v_pk_mul_f32 v[54:55], v[80:81], v[70:71] op_sel:[0,0] op_sel_hi:[1,0]
    v_pk_fma_f32 v[78:79], v[80:81], v[70:71], v[54:55] op_sel:[1,1,0] op_sel_hi:[0,1,1] neg_lo:[1,0,0]
    v_cvt_pk_bf16_f32 v92, v78, -v79
    ds_write_addtid_b32 v92 offset:44352
    v_pk_mul_f32 v[54:55], v[78:79], v[70:71] op_sel:[0,0] op_sel_hi:[1,0]
    v_pk_fma_f32 v[80:81], v[78:79], v[70:71], v[54:55] op_sel:[1,1,0] op_sel_hi:[0,1,1] neg_lo:[1,0,0]
    v_cvt_pk_bf16_f32 v93, v80, -v81
    ds_write_addtid_b32 v93 offset:45408
    v_pk_mul_f32 v[54:55], v[80:81], v[70:71] op_sel:[0,0] op_sel_hi:[1,0]
    v_pk_fma_f32 v[78:79], v[80:81], v[70:71], v[54:55] op_sel:[1,1,0] op_sel_hi:[0,1,1] neg_lo:[1,0,0]
    v_cvt_pk_bf16_f32 v92, v78, -v79
    ds_write_addtid_b32 v92 offset:46464
    v_pk_mul_f32 v[54:55], v[78:79], v[70:71] op_sel:[0,0] op_sel_hi:[1,0]
    v_pk_fma_f32 v[80:81], v[78:79], v[70:71], v[54:55] op_sel:[1,1,0] op_sel_hi:[0,1,1] neg_lo:[1,0,0]
    v_cvt_pk_bf16_f32 v93, v80, -v81
    ds_write_addtid_b32 v93 offset:47520
    v_pk_mul_f32 v[54:55], v[80:81], v[70:71] op_sel:[0,0] op_sel_hi:[1,0]
    v_pk_fma_f32 v[78:79], v[80:81], v[70:71], v[54:55] op_sel:[1,1,0] op_sel_hi:[0,1,1] neg_lo:[1,0,0]
    v_cvt_pk_bf16_f32 v92, v78, -v79
    ds_write_addtid_b32 v92 offset:48576
    v_pk_mul_f32 v[54:55], v[78:79], v[70:71] op_sel:[0,0] op_sel_hi:[1,0]
    v_pk_fma_f32 v[80:81], v[78:79], v[70:71], v[54:55] op_sel:[1,1,0] op_sel_hi:[0,1,1] neg_lo:[1,0,0]
    v_cvt_pk_bf16_f32 v93, v80, -v81
    ds_write_addtid_b32 v93 offset:49632
    s_and_b32 s40, s2, 3
    s_mul_i32 s40, s40, 8320
    v_and_b32 v156, 7, v2
    v_lshlrev_b32 v156, 7, v156
    s_lshl_b32 s31, s22, 10
    s_add_u32 s31, s31, s40
    s_add_u32 s31, s31, 0x40000
    buffer_load_dwordx4 v[160:163], v156, s[60:63], s31 offen sc1
    s_lshr_b32 s30, s43, 2
    s_mul_i32 s30, s30, 33024
    s_and_b32 s26, s43, 3
    s_lshl_b32 s26, s26, 5
    s_add_u32 s30, s30, s26
    s_add_u32 s30, s30, 0x800000
    s_mov_b32 s38, 0x4000
    v_and_b32 v17, 1, v0
    v_lshrrev_b32 v16, 1, v0
    v_lshlrev_b32 v158, 5, v0
    v_lshlrev_b32 v157, 7, v16
    v_lshl_add_u32 v157, v17, 4, v157
    v_mul_u32_u24 v159, 13248, v17
    v_lshl_add_u32 v159, v16, 4, v159
    v_add_u32 v159, 131712, v159
    v_and_b32 v5, 15, v2
    v_mul_u32_u24 v5, 1056, v5
    v_lshrrev_b32 v6, 4, v2
    v_lshl_add_u32 v5, v6, 4, v5
    s_mul_i32 s26, s28, 60192
    s_lshl_b32 s27, s23, 8
    s_add_u32 s26, s26, s27
    v_add_u32 v5, s26, v5
    s_mul_i32 s29, s28, 16640
    s_add_u32 s29, s29, 98368
    v_lshrrev_b32 v6, 4, v2
    v_mul_u32_u24 v6, 1056, v6
    v_and_b32 v16, 15, v2
    v_lshl_add_u32 v6, v16, 4, v6
    v_add_u32 v16, s26, v6
    s_mul_i32 s26, s28, 60192
    s_mul_i32 s27, s23, 4224
    s_add_u32 s26, s26, s27
    v_add_u32 v6, s26, v6
    s_waitcnt lgkmcnt(0)
    ds_read_b128 v[44:47], v5 offset:33792
    ds_read_b128 v[48:51], v5 offset:0
    ds_read_b128 v[52:55], v5 offset:16896
    ds_read_b128 v[56:59], v5 offset:50688
    ds_read_b128 v[60:63], v5 offset:33856
    ds_read_b128 v[64:67], v5 offset:64
    ds_read_b128 v[68:71], v5 offset:16960
    ds_read_b128 v[72:75], v5 offset:50752
    ds_read_b128 v[76:79], v5 offset:33920
    ds_read_b128 v[80:83], v5 offset:128
    ds_read_b128 v[84:87], v5 offset:17024
    ds_read_b128 v[88:91], v5 offset:50816
    ds_read_b128 v[92:95], v5 offset:33984
    ds_read_b128 v[96:99], v5 offset:192
    ds_read_b128 v[100:103], v5 offset:17088
    ds_read_b128 v[104:107], v5 offset:50880
    s_waitcnt lgkmcnt(14)
    v_mfma_f32_16x16x32_bf16 v[32:35], v[48:51], v[44:47], 0
    s_waitcnt lgkmcnt(13)
    v_mfma_f32_16x16x32_bf16 v[36:39], v[52:55], v[44:47], 0
    s_waitcnt lgkmcnt(12)
    v_mfma_f32_16x16x32_bf16 v[40:43], v[56:59], v[44:47], 0
    s_waitcnt lgkmcnt(10)
    v_mfma_f32_16x16x32_bf16 v[32:35], v[64:67], v[60:63], v[32:35]
    s_waitcnt lgkmcnt(9)
    v_mfma_f32_16x16x32_bf16 v[36:39], v[68:71], v[60:63], v[36:39]
    s_waitcnt lgkmcnt(8)
    v_mfma_f32_16x16x32_bf16 v[40:43], v[72:75], v[60:63], v[40:43]
    s_waitcnt lgkmcnt(6)
    v_mfma_f32_16x16x32_bf16 v[32:35], v[80:83], v[76:79], v[32:35]
    s_waitcnt lgkmcnt(5)
    v_mfma_f32_16x16x32_bf16 v[36:39], v[84:87], v[76:79], v[36:39]
    s_waitcnt lgkmcnt(4)
    v_mfma_f32_16x16x32_bf16 v[40:43], v[88:91], v[76:79], v[40:43]
    s_waitcnt lgkmcnt(2)
    v_mfma_f32_16x16x32_bf16 v[32:35], v[96:99], v[92:95], v[32:35]
    s_waitcnt lgkmcnt(1)
    v_mfma_f32_16x16x32_bf16 v[36:39], v[100:103], v[92:95], v[36:39]
    s_waitcnt lgkmcnt(0)
    v_mfma_f32_16x16x32_bf16 v[40:43], v[104:107], v[92:95], v[40:43]
    s_nop 5
    v_add_f32 v32, v32, v29
    ds_write_b128 v16, v[32:35]
    ds_write_b128 v16, v[36:39] offset:4224
    ds_write_b128 v16, v[40:43] offset:8448
    s_waitcnt lgkmcnt(0)
    s_barrier
    s_cmp_eq_u32 s23, 3
    s_cbranch_scc1 P1_nomm
    ds_read_b128 v[44:47], v6
    ds_read_b128 v[48:51], v6 offset:256
    ds_read_b128 v[52:55], v6 offset:512
    ds_read_b128 v[56:59], v6 offset:768
    s_waitcnt vmcnt(1) lgkmcnt(2)
    v_pk_add_f32 v[44:45], v[44:45], v[48:49]
    v_pk_add_f32 v[46:47], v[46:47], v[50:51]
    s_waitcnt lgkmcnt(0)
    v_pk_add_f32 v[52:53], v[52:53], v[56:57]
    v_pk_add_f32 v[54:55], v[54:55], v[58:59]
    v_pk_add_f32 v[44:45], v[44:45], v[52:53]
    v_pk_add_f32 v[46:47], v[46:47], v[54:55]
    ds_write_b32 v12, v44
    ds_write_b32 v13, v45
    ds_write_b32 v14, v46
    ds_write_b32 v15, v47
P1_nomm:
    v_lshl_add_u32 v7, v4, 4, s29
    s_mul_i32 s26, s23, 4156
    s_add_u32 s26, s26, s29
    s_add_u32 s26, s26, 4096
    v_lshl_add_u32 v16, v2, 2, s26
    s_add_u32 s27, s23, 12
    v_mov_b32 v8, 0
    v_mov_b32 v9, 0
    v_mov_b32 v10, 0
    v_mov_b32 v11, 0
    s_mul_i32 s35, s28, 13248
    s_mul_i32 s34, s23, 4576
    s_add_u32 s35, s35, s34
    s_add_u32 s35, s35, 131712
    v_lshl_add_u32 v18, v2, 4, s35
    v_mov_b32 v17, s35
    s_cmp_lt_u32 s23, 2
    s_cselect_b32 s32, 0x0fffffff, 0
    s_mov_b32 s33, 0
    s_mov_b64 exec, s[32:33]
    s_cbranch_execz P1_nz
    ds_write_b128 v18, v[8:11]
    s_cmp_eq_u32 s23, 1
    s_cbranch_scc0 P1_nz
    ds_write_b16 v17, v8 offset:448
P1_nz:
    s_mov_b64 exec, -1
    s_waitcnt vmcnt(0)
    v_xor_b32 v160, s42, v160
    v_xor_b32 v161, s42, v161
    v_xor_b32 v162, s42, v162
    v_xor_b32 v163, s42, v163
    v_or3_b32 v160, v160, v161, v162
    v_or_b32 v160, v160, v163
    v_cmp_eq_u32 vcc, 0, v160
    s_nop 3
    s_cmp_eq_u64 vcc, exec
    s_cselect_b32 s39, 1, 0
    s_cbranch_scc0 P1_e1
    buffer_load_dwordx4 v[112:115], v157, s[60:63], s30 offen sc1
    buffer_load_dwordx4 v[132:135], v158, s[60:63], s38 offen sc1
    buffer_load_dwordx4 v[136:139], v158, s[60:63], s38 offen offset:16 sc1
    s_branch P1_e2
P1_e1:
    buffer_load_dwordx4 v[160:163], v156, s[60:63], s31 offen sc1
P1_e2:
    s_waitcnt lgkmcnt(0)
    s_barrier
    ds_read_b32 v44, v20
    ds_read_b32 v45, v21
    ds_read_b32 v46, v22
    ds_read_b32 v47, v23
    ds_read_b32 v48, v24
    ds_read_b32 v49, v25
    ds_read_b32 v50, v26
    ds_read_b32 v51, v27
    v_cmp_gt_u32 vcc, s27, v2
    s_and_saveexec_b64 s[32:33], vcc
    ds_write_b32 v16, v8
    s_mov_b64 exec, s[32:33]
    s_waitcnt lgkmcnt(7)
    v_cvt_pk_bf16_f32 v32, v44, v45
    s_waitcnt lgkmcnt(5)
    v_cvt_pk_bf16_f32 v33, v46, v47
    s_waitcnt lgkmcnt(3)
    v_cvt_pk_bf16_f32 v34, v48, v49
    s_waitcnt lgkmcnt(1)
    v_cvt_pk_bf16_f32 v35, v50, v51
    v_mov_b32 v36, v33
    v_mov_b32 v37, v34
    ds_write_b128 v7, v[32:35]
    ds_write_b64 v7, v[32:33] offset:8312
    ds_write_b64 v7, v[34:35] offset:8320
    ds_write_b32 v7, v32 offset:4156
    ds_write_b64 v7, v[36:37] offset:4160
    ds_write_b32 v7, v35 offset:4168
    ds_write_b32 v7, v32 offset:12468
    ds_write_b64 v7, v[36:37] offset:12472
    ds_write_b32 v7, v35 offset:12480
    v_mov_b32 v7, v159
    s_cmp_eq_u32 s39, 1
    s_cbranch_scc1 P1_have
    s_waitcnt vmcnt(0)
    v_xor_b32 v160, s42, v160
    v_xor_b32 v161, s42, v161
    v_xor_b32 v162, s42, v162
    v_xor_b32 v163, s42, v163
    v_or3_b32 v160, v160, v161, v162
    v_or_b32 v160, v160, v163
    v_cmp_eq_u32 vcc, 0, v160
    s_nop 3
    s_cmp_eq_u64 vcc, exec
    s_cbranch_scc1 P1_f_got
    s_mov_b32 s36, 0x40000
P1_f_poll:
    buffer_load_dwordx4 v[160:163], v156, s[60:63], s31 offen sc1
    s_waitcnt vmcnt(0)
    v_xor_b32 v160, s42, v160
    v_xor_b32 v161, s42, v161
    v_xor_b32 v162, s42, v162
    v_xor_b32 v163, s42, v163
    v_or3_b32 v160, v160, v161, v162
    v_or_b32 v160, v160, v163
    v_cmp_eq_u32 vcc, 0, v160
    s_nop 3
    s_cmp_eq_u64 vcc, exec
    s_cbranch_scc1 P1_f_got
    s_sub_u32 s36, s36, 1
    s_cmp_eq_u32 s36, 0
    s_cbranch_scc1 P1_f_got
    s_sleep 1
    s_branch P1_f_poll
P1_f_got:
    buffer_load_dwordx4 v[112:115], v157, s[60:63], s30 offen sc1
    buffer_load_dwordx4 v[132:135], v158, s[60:63], s38 offen sc1
    buffer_load_dwordx4 v[136:139], v158, s[60:63], s38 offen offset:16 sc1
P1_have:
    s_cmp_ge_u32 s22, 4
    s_cbranch_scc1 LOADER
    v_and_b32 v4, 15, v2
    v_lshrrev_b32 v5, 4, v2
    s_lshr_b32 s28, s22, 1
    s_and_b32 s30, s22, 1
    s_mul_i32 s27, s28, 16640
    s_add_u32 s27, s27, 98368
    v_and_b32 v36, 3, v4
    v_sub_u32 v36, 3, v36
    v_mul_u32_u24 v36, 4160, v36
    v_lshrrev_b32 v37, 2, v4
    v_sub_u32 v37, v5, v37
    v_lshl_add_u32 v36, v37, 4, v36
    v_add_u32 v36, 496, v36
    v_add_u32 v36, s27, v36
    s_mul_i32 s27, s28, 13248
    s_add_u32 s27, s27, 131712
    v_and_b32 v37, 1, v4
    v_sub_u32 v37, 1, v37
    v_mul_u32_u24 v37, 4576, v37
    v_lshrrev_b32 v38, 1, v4
    v_lshl_add_u32 v37, v38, 6, v37
    v_lshl_add_u32 v37, v5, 4, v37
    v_add_u32 v37, 448, v37
    v_add_u32 v37, s27, v37
    v_lshlrev_b32 v6, 7, v5
    v_lshl_add_u32 v6, v4, 2, v6
    s_add_u32 s26, s27, 9152
    v_add_u32 v6, s26, v6
    v_lshl_add_u32 v39, v2, 4, s26
    v_mul_u32_u24 v38, 114944, v5
    v_lshl_add_u32 v38, v4, 4, v38
    s_lshl_b32 s33, s43, 1
    s_add_u32 s33, s33, s28
    s_lshl_b32 s33, s33, 8
    s_add_u32 s33, s33, 0x100000
    s_waitcnt vmcnt(2)
    ds_write_b128 v7, v[112:115] offset:9152
    v_lshlrev_b32 v148, 16, v112
    v_and_b32 v149, 0xffff0000, v112
    v_lshlrev_b32 v150, 16, v113
    v_and_b32 v151, 0xffff0000, v113
    v_lshlrev_b32 v152, 16, v114
    v_and_b32 v153, 0xffff0000, v114
    v_lshlrev_b32 v154, 16, v115
    v_and_b32 v155, 0xffff0000, v115
    s_waitcnt vmcnt(0)
    v_subrev_f32_dpp v148, v132, v148 quad_perm:[0,0,2,2] row_mask:0xf bank_mask:0xf
    v_subrev_f32_dpp v149, v133, v149 quad_perm:[0,0,2,2] row_mask:0xf bank_mask:0xf
    v_subrev_f32_dpp v150, v134, v150 quad_perm:[0,0,2,2] row_mask:0xf bank_mask:0xf
    v_subrev_f32_dpp v151, v135, v151 quad_perm:[0,0,2,2] row_mask:0xf bank_mask:0xf
    v_subrev_f32_dpp v152, v136, v152 quad_perm:[0,0,2,2] row_mask:0xf bank_mask:0xf
    v_subrev_f32_dpp v153, v137, v153 quad_perm:[0,0,2,2] row_mask:0xf bank_mask:0xf
    v_subrev_f32_dpp v154, v138, v154 quad_perm:[0,0,2,2] row_mask:0xf bank_mask:0xf
    v_subrev_f32_dpp v155, v139, v155 quad_perm:[0,0,2,2] row_mask:0xf bank_mask:0xf
    v_cvt_pk_bf16_f32 v116, v148, v149
    v_cvt_pk_bf16_f32 v117, v150, v151
    v_cvt_pk_bf16_f32 v118, v152, v153
    v_cvt_pk_bf16_f32 v119, v154, v155
    v_lshlrev_b32 v148, 16, v116
    v_and_b32 v149, 0xffff0000, v116
    v_lshlrev_b32 v150, 16, v117
    v_and_b32 v151, 0xffff0000, v117
    v_lshlrev_b32 v152, 16, v118
    v_and_b32 v153, 0xffff0000, v118
    v_lshlrev_b32 v154, 16, v119
    v_and_b32 v155, 0xffff0000, v119
    v_mul_f32_dpp v148, v132, v148 quad_perm:[1,1,3,3] row_mask:0xf bank_mask:0xf
    v_mul_f32_dpp v149, v133, v149 quad_perm:[1,1,3,3] row_mask:0xf bank_mask:0xf
    v_mul_f32_dpp v150, v134, v150 quad_perm:[1,1,3,3] row_mask:0xf bank_mask:0xf
    v_mul_f32_dpp v151, v135, v151 quad_perm:[1,1,3,3] row_mask:0xf bank_mask:0xf
    v_mul_f32_dpp v152, v136, v152 quad_perm:[1,1,3,3] row_mask:0xf bank_mask:0xf
    v_mul_f32_dpp v153, v137, v153 quad_perm:[1,1,3,3] row_mask:0xf bank_mask:0xf
    v_mul_f32_dpp v154, v138, v154 quad_perm:[1,1,3,3] row_mask:0xf bank_mask:0xf
    v_mul_f32_dpp v155, v139, v155 quad_perm:[1,1,3,3] row_mask:0xf bank_mask:0xf
    v_cvt_pk_bf16_f32 v116, v148, v149
    v_cvt_pk_bf16_f32 v117, v150, v151
    v_cvt_pk_bf16_f32 v118, v152, v153
    v_cvt_pk_bf16_f32 v119, v154, v155
    v_cvt_pk_bf16_f32 v44, v149, v150
    v_cvt_pk_bf16_f32 v46, v151, v152
    v_cvt_pk_bf16_f32 v47, v153, v154
    ds_write_b128 v7, v[116:119] offset:448
    ds_write_b16 v7, v116 offset:5026
    ds_write_b32 v7, v44 offset:5028
    ds_write_b64 v7, v[46:47] offset:5032
    ds_write_b16_d16_hi v7, v119 offset:5040
    s_waitcnt lgkmcnt(0)
    s_barrier
    s_cmp_eq_u32 s30, 0
    s_cbranch_scc0 CV_roleB
    ds_read_b32 v12, v6 offset:3584
    ds_read_b32 v13, v6 offset:3648
    ds_read_b32 v14, v6 offset:3072
    ds_read_b32 v15, v6 offset:3136
    ds_read_b32 v16, v6 offset:512
    ds_read_b32 v17, v6 offset:576
    ds_read2_b32 v[18:19], v6 offset0:0 offset1:16
    ds_read_b128 v[40:43], v36 offset:3584
    ds_read_b128 v[72:75], v37 offset:0
    ds_read_b128 v[44:47], v36 offset:3072
    ds_read_b128 v[76:79], v37 offset:512
    ds_read_b128 v[48:51], v36 offset:2560
    ds_read_b128 v[80:83], v37 offset:1024
    s_waitcnt lgkmcnt(6)
    ds_read_b128 v[52:55], v36 offset:2048
    ds_read_b128 v[84:87], v37 offset:1536
    ds_read_b128 v[56:59], v36 offset:1536
    ds_read_b128 v[88:91], v37 offset:2048
    ds_read_b128 v[60:63], v36 offset:1024
    ds_read_b128 v[92:95], v37 offset:2560
    ds_read_b128 v[64:67], v36 offset:512
    ds_read_b128 v[96:99], v37 offset:3072
    ds_read_b128 v[68:71], v36 offset:0
    ds_read_b128 v[100:103], v37 offset:3584
    v_lshlrev_b32 v20, 16, v12
    v_and_b32 v21, 0xffff0000, v12
    v_lshlrev_b32 v22, 16, v13
    v_and_b32 v23, 0xffff0000, v13
    v_lshlrev_b32 v24, 16, v14
    v_and_b32 v25, 0xffff0000, v14
    v_lshlrev_b32 v26, 16, v15
    v_and_b32 v27, 0xffff0000, v15
    v_lshlrev_b32 v28, 16, v16
    v_and_b32 v29, 0xffff0000, v16
    v_lshlrev_b32 v30, 16, v17
    v_and_b32 v31, 0xffff0000, v17
    v_lshlrev_b32 v32, 16, v18
    v_and_b32 v33, 0xffff0000, v18
    v_lshlrev_b32 v34, 16, v19
    v_and_b32 v35, 0xffff0000, v19
    s_mov_b32 s36, 4
CV_loop0:
    v_subrev_u32 v36, 64, v36
    v_subrev_u32 v37, 64, v37
    s_waitcnt lgkmcnt(14)
    v_mfma_f32_16x16x32_bf16 v[32:35], v[72:75], v[40:43], v[32:35]
    ds_read_b128 v[104:107], v36 offset:3584
    s_waitcnt lgkmcnt(13)
    v_mfma_f32_16x16x32_bf16 v[28:31], v[76:79], v[40:43], v[28:31]
    ds_read_b128 v[136:139], v37 offset:0
    v_mfma_f32_16x16x32_bf16 v[28:31], v[72:75], v[44:47], v[28:31]
    ds_read_b128 v[108:111], v36 offset:3072
    s_waitcnt lgkmcnt(11)
    v_mfma_f32_16x16x32_bf16 v[24:27], v[84:87], v[52:55], v[24:27]
    ds_read_b128 v[140:143], v37 offset:512
    s_waitcnt lgkmcnt(10)
    v_mfma_f32_16x16x32_bf16 v[20:23], v[88:91], v[52:55], v[20:23]
    ds_read_b128 v[112:115], v36 offset:2560
    v_mfma_f32_16x16x32_bf16 v[20:23], v[84:87], v[56:59], v[20:23]
    ds_read_b128 v[144:147], v37 offset:1024
    v_mfma_f32_16x16x32_bf16 v[24:27], v[88:91], v[48:51], v[24:27]
    ds_read_b128 v[116:119], v36 offset:2048
    v_mfma_f32_16x16x32_bf16 v[24:27], v[80:83], v[56:59], v[24:27]
    ds_read_b128 v[148:151], v37 offset:1536
    s_waitcnt lgkmcnt(12)
    v_mfma_f32_16x16x32_bf16 v[20:23], v[92:95], v[48:51], v[20:23]
    ds_read_b128 v[120:123], v36 offset:1536
    v_mfma_f32_16x16x32_bf16 v[20:23], v[80:83], v[60:63], v[20:23]
    ds_read_b128 v[152:155], v37 offset:2048
    v_mfma_f32_16x16x32_bf16 v[24:27], v[92:95], v[44:47], v[24:27]
    ds_read_b128 v[124:127], v36 offset:1024
    v_mfma_f32_16x16x32_bf16 v[24:27], v[76:79], v[60:63], v[24:27]
    ds_read_b128 v[156:159], v37 offset:2560
    s_waitcnt lgkmcnt(14)
    v_mfma_f32_16x16x32_bf16 v[20:23], v[96:99], v[44:47], v[20:23]
    ds_read_b128 v[128:131], v36 offset:512
    v_mfma_f32_16x16x32_bf16 v[20:23], v[76:79], v[64:67], v[20:23]
    ds_read_b128 v[160:163], v37 offset:3072
    v_mfma_f32_16x16x32_bf16 v[24:27], v[96:99], v[40:43], v[24:27]
    ds_read_b128 v[132:135], v36 offset:0
    v_mfma_f32_16x16x32_bf16 v[24:27], v[72:75], v[64:67], v[24:27]
    ds_read_b128 v[164:167], v37 offset:3584
    s_waitcnt lgkmcnt(15)
    v_mfma_f32_16x16x32_bf16 v[20:23], v[100:103], v[40:43], v[20:23]
    v_mfma_f32_16x16x32_bf16 v[20:23], v[72:75], v[68:71], v[20:23]
    v_subrev_u32 v36, 64, v36
    v_subrev_u32 v37, 64, v37
    s_waitcnt lgkmcnt(14)
    v_mfma_f32_16x16x32_bf16 v[32:35], v[136:139], v[104:107], v[32:35]
    ds_read_b128 v[40:43], v36 offset:3584
    s_waitcnt lgkmcnt(13)
    v_mfma_f32_16x16x32_bf16 v[28:31], v[140:143], v[104:107], v[28:31]
    ds_read_b128 v[72:75], v37 offset:0
    v_mfma_f32_16x16x32_bf16 v[28:31], v[136:139], v[108:111], v[28:31]
    ds_read_b128 v[44:47], v36 offset:3072
    s_waitcnt lgkmcnt(11)
    v_mfma_f32_16x16x32_bf16 v[24:27], v[148:151], v[116:119], v[24:27]
    ds_read_b128 v[76:79], v37 offset:512
    s_waitcnt lgkmcnt(10)
    v_mfma_f32_16x16x32_bf16 v[20:23], v[152:155], v[116:119], v[20:23]
    ds_read_b128 v[48:51], v36 offset:2560
    v_mfma_f32_16x16x32_bf16 v[20:23], v[148:151], v[120:123], v[20:23]
    ds_read_b128 v[80:83], v37 offset:1024
    v_mfma_f32_16x16x32_bf16 v[24:27], v[152:155], v[112:115], v[24:27]
    ds_read_b128 v[52:55], v36 offset:2048
    v_mfma_f32_16x16x32_bf16 v[24:27], v[144:147], v[120:123], v[24:27]
    ds_read_b128 v[84:87], v37 offset:1536
    s_waitcnt lgkmcnt(12)
    v_mfma_f32_16x16x32_bf16 v[20:23], v[156:159], v[112:115], v[20:23]
    ds_read_b128 v[56:59], v36 offset:1536
    v_mfma_f32_16x16x32_bf16 v[20:23], v[144:147], v[124:127], v[20:23]
    ds_read_b128 v[88:91], v37 offset:2048
    v_mfma_f32_16x16x32_bf16 v[24:27], v[156:159], v[108:111], v[24:27]
    ds_read_b128 v[60:63], v36 offset:1024
    v_mfma_f32_16x16x32_bf16 v[24:27], v[140:143], v[124:127], v[24:27]
    ds_read_b128 v[92:95], v37 offset:2560
    s_waitcnt lgkmcnt(14)
    v_mfma_f32_16x16x32_bf16 v[20:23], v[160:163], v[108:111], v[20:23]
    ds_read_b128 v[64:67], v36 offset:512
    v_mfma_f32_16x16x32_bf16 v[20:23], v[140:143], v[128:131], v[20:23]
    ds_read_b128 v[96:99], v37 offset:3072
    v_mfma_f32_16x16x32_bf16 v[24:27], v[160:163], v[104:107], v[24:27]
    ds_read_b128 v[68:71], v36 offset:0
    v_mfma_f32_16x16x32_bf16 v[24:27], v[136:139], v[128:131], v[24:27]
    ds_read_b128 v[100:103], v37 offset:3584
    s_waitcnt lgkmcnt(15)
    v_mfma_f32_16x16x32_bf16 v[20:23], v[164:167], v[104:107], v[20:23]
    v_mfma_f32_16x16x32_bf16 v[20:23], v[136:139], v[132:135], v[20:23]
    s_sub_u32 s36, s36, 1
    s_cmp_lg_u32 s36, 0
    s_cbranch_scc1 CV_loop0
    s_nop 6
    v_cvt_pk_bf16_f32 v12, v20, v21
    v_cvt_pk_bf16_f32 v13, v22, v23
    ds_write_b32 v6, v12 offset:3584
    ds_write_b32 v6, v13 offset:3648
    v_cvt_pk_bf16_f32 v14, v24, v25
    v_cvt_pk_bf16_f32 v15, v26, v27
    ds_write_b32 v6, v14 offset:3072
    ds_write_b32 v6, v15 offset:3136
    v_cvt_pk_bf16_f32 v16, v28, v29
    v_cvt_pk_bf16_f32 v17, v30, v31
    ds_write_b32 v6, v16 offset:512
    ds_write_b32 v6, v17 offset:576
    v_cvt_pk_bf16_f32 v18, v32, v33
    v_cvt_pk_bf16_f32 v19, v34, v35
    ds_write_b32 v6, v18 offset:0
    ds_write_b32 v6, v19 offset:64
    s_add_u32 s34, s33, 0x150c00
    s_add_u32 s35, s33, 0x0
    s_waitcnt lgkmcnt(0)
    ds_read_b128 v[20:23], v39 offset:3072
    ds_read_b128 v[24:27], v39 offset:0
    s_branch CV_out
CV_roleB:
    ds_read_b32 v12, v6 offset:2560
    ds_read_b32 v13, v6 offset:2624
    ds_read_b32 v14, v6 offset:2048
    ds_read_b32 v15, v6 offset:2112
    ds_read_b32 v16, v6 offset:1536
    ds_read_b32 v17, v6 offset:1600
    ds_read_b32 v18, v6 offset:1024
    ds_read_b32 v19, v6 offset:1088
    ds_read_b128 v[40:43], v36 offset:3584
    ds_read_b128 v[72:75], v37 offset:0
    ds_read_b128 v[44:47], v36 offset:3072
    ds_read_b128 v[76:79], v37 offset:512
    ds_read_b128 v[48:51], v36 offset:2560
    ds_read_b128 v[80:83], v37 offset:1024
    s_waitcnt lgkmcnt(6)
    ds_read_b128 v[52:55], v36 offset:2048
    ds_read_b128 v[84:87], v37 offset:1536
    ds_read_b128 v[56:59], v36 offset:1536
    ds_read_b128 v[88:91], v37 offset:2048
    ds_read_b128 v[60:63], v36 offset:1024
    ds_read_b128 v[92:95], v37 offset:2560
    v_lshlrev_b32 v20, 16, v12
    v_and_b32 v21, 0xffff0000, v12
    v_lshlrev_b32 v22, 16, v13
    v_and_b32 v23, 0xffff0000, v13
    v_lshlrev_b32 v24, 16, v14
    v_and_b32 v25, 0xffff0000, v14
    v_lshlrev_b32 v26, 16, v15
    v_and_b32 v27, 0xffff0000, v15
    v_lshlrev_b32 v28, 16, v16
    v_and_b32 v29, 0xffff0000, v16
    v_lshlrev_b32 v30, 16, v17
    v_and_b32 v31, 0xffff0000, v17
    v_lshlrev_b32 v32, 16, v18
    v_and_b32 v33, 0xffff0000, v18
    v_lshlrev_b32 v34, 16, v19
    v_and_b32 v35, 0xffff0000, v19
    s_mov_b32 s36, 4
CV_loop1:
    v_subrev_u32 v36, 64, v36
    v_subrev_u32 v37, 64, v37
    s_waitcnt lgkmcnt(8)
    v_mfma_f32_16x16x32_bf16 v[32:35], v[76:79], v[44:47], v[32:35]
    ds_read_b128 v[104:107], v36 offset:3584
    s_waitcnt lgkmcnt(7)
    v_mfma_f32_16x16x32_bf16 v[24:27], v[80:83], v[48:51], v[24:27]
    ds_read_b128 v[136:139], v37 offset:0
    v_mfma_f32_16x16x32_bf16 v[28:31], v[80:83], v[44:47], v[28:31]
    ds_read_b128 v[108:111], v36 offset:3072
    v_mfma_f32_16x16x32_bf16 v[28:31], v[76:79], v[48:51], v[28:31]
    ds_read_b128 v[140:143], v37 offset:512
    v_mfma_f32_16x16x32_bf16 v[32:35], v[80:83], v[40:43], v[32:35]
    ds_read_b128 v[112:115], v36 offset:2560
    v_mfma_f32_16x16x32_bf16 v[32:35], v[72:75], v[48:51], v[32:35]
    ds_read_b128 v[144:147], v37 offset:1024
    s_waitcnt lgkmcnt(10)
    v_mfma_f32_16x16x32_bf16 v[20:23], v[84:87], v[48:51], v[20:23]
    ds_read_b128 v[116:119], v36 offset:2048
    v_mfma_f32_16x16x32_bf16 v[20:23], v[80:83], v[52:55], v[20:23]
    ds_read_b128 v[148:151], v37 offset:1536
    v_mfma_f32_16x16x32_bf16 v[24:27], v[84:87], v[44:47], v[24:27]
    ds_read_b128 v[120:123], v36 offset:1536
    v_mfma_f32_16x16x32_bf16 v[24:27], v[76:79], v[52:55], v[24:27]
    ds_read_b128 v[152:155], v37 offset:2048
    v_mfma_f32_16x16x32_bf16 v[28:31], v[84:87], v[40:43], v[28:31]
    ds_read_b128 v[124:127], v36 offset:1024
    v_mfma_f32_16x16x32_bf16 v[28:31], v[72:75], v[52:55], v[28:31]
    ds_read_b128 v[156:159], v37 offset:2560
    s_waitcnt lgkmcnt(14)
    v_mfma_f32_16x16x32_bf16 v[20:23], v[88:91], v[44:47], v[20:23]
    v_mfma_f32_16x16x32_bf16 v[20:23], v[76:79], v[56:59], v[20:23]
    v_mfma_f32_16x16x32_bf16 v[24:27], v[88:91], v[40:43], v[24:27]
    v_mfma_f32_16x16x32_bf16 v[24:27], v[72:75], v[56:59], v[24:27]
    s_waitcnt lgkmcnt(12)
    v_mfma_f32_16x16x32_bf16 v[20:23], v[92:95], v[40:43], v[20:23]
    v_mfma_f32_16x16x32_bf16 v[20:23], v[72:75], v[60:63], v[20:23]
    v_subrev_u32 v36, 64, v36
    v_subrev_u32 v37, 64, v37
    s_waitcnt lgkmcnt(8)
    v_mfma_f32_16x16x32_bf16 v[32:35], v[140:143], v[108:111], v[32:35]
    ds_read_b128 v[40:43], v36 offset:3584
    s_waitcnt lgkmcnt(7)
    v_mfma_f32_16x16x32_bf16 v[24:27], v[144:147], v[112:115], v[24:27]
    ds_read_b128 v[72:75], v37 offset:0
    v_mfma_f32_16x16x32_bf16 v[28:31], v[144:147], v[108:111], v[28:31]
    ds_read_b128 v[44:47], v36 offset:3072
    v_mfma_f32_16x16x32_bf16 v[28:31], v[140:143], v[112:115], v[28:31]
    ds_read_b128 v[76:79], v37 offset:512
    v_mfma_f32_16x16x32_bf16 v[32:35], v[144:147], v[104:107], v[32:35]
    ds_read_b128 v[48:51], v36 offset:2560
    v_mfma_f32_16x16x32_bf16 v[32:35], v[136:139], v[112:115], v[32:35]
    ds_read_b128 v[80:83], v37 offset:1024
    s_waitcnt lgkmcnt(10)
    v_mfma_f32_16x16x32_bf16 v[20:23], v[148:151], v[112:115], v[20:23]
    ds_read_b128 v[52:55], v36 offset:2048
    v_mfma_f32_16x16x32_bf16 v[20:23], v[144:147], v[116:119], v[20:23]
    ds_read_b128 v[84:87], v37 offset:1536
    v_mfma_f32_16x16x32_bf16 v[24:27], v[148:151], v[108:111], v[24:27]
    ds_read_b128 v[56:59], v36 offset:1536
    v_mfma_f32_16x16x32_bf16 v[24:27], v[140:143], v[116:119], v[24:27]
    ds_read_b128 v[88:91], v37 offset:2048
    v_mfma_f32_16x16x32_bf16 v[28:31], v[148:151], v[104:107], v[28:31]
    ds_read_b128 v[60:63], v36 offset:1024
    v_mfma_f32_16x16x32_bf16 v[28:31], v[136:139], v[116:119], v[28:31]
    ds_read_b128 v[92:95], v37 offset:2560
    s_waitcnt lgkmcnt(14)
    v_mfma_f32_16x16x32_bf16 v[20:23], v[152:155], v[108:111], v[20:23]
    v_mfma_f32_16x16x32_bf16 v[20:23], v[140:143], v[120:123], v[20:23]
    v_mfma_f32_16x16x32_bf16 v[24:27], v[152:155], v[104:107], v[24:27]
    v_mfma_f32_16x16x32_bf16 v[24:27], v[136:139], v[120:123], v[24:27]
    s_waitcnt lgkmcnt(12)
    v_mfma_f32_16x16x32_bf16 v[20:23], v[156:159], v[104:107], v[20:23]
    v_mfma_f32_16x16x32_bf16 v[20:23], v[136:139], v[124:127], v[20:23]
    s_sub_u32 s36, s36, 1
    s_cmp_lg_u32 s36, 0
    s_cbranch_scc1 CV_loop1
    s_nop 6
    v_cvt_pk_bf16_f32 v12, v20, v21
    v_cvt_pk_bf16_f32 v13, v22, v23
    ds_write_b32 v6, v12 offset:2560
    ds_write_b32 v6, v13 offset:2624
    v_cvt_pk_bf16_f32 v14, v24, v25
    v_cvt_pk_bf16_f32 v15, v26, v27
    ds_write_b32 v6, v14 offset:2048
    ds_write_b32 v6, v15 offset:2112
    v_cvt_pk_bf16_f32 v16, v28, v29
    v_cvt_pk_bf16_f32 v17, v30, v31
    ds_write_b32 v6, v16 offset:1536
    ds_write_b32 v6, v17 offset:1600
    v_cvt_pk_bf16_f32 v18, v32, v33
    v_cvt_pk_bf16_f32 v19, v34, v35
    ds_write_b32 v6, v18 offset:1024
    ds_write_b32 v6, v19 offset:1088
    s_add_u32 s34, s33, 0xe0800
    s_add_u32 s35, s33, 0x70400
    s_waitcnt lgkmcnt(0)
    ds_read_b128 v[20:23], v39 offset:2048
    ds_read_b128 v[24:27], v39 offset:1024
CV_out:
    s_waitcnt lgkmcnt(1)
    buffer_store_dwordx4 v[20:23], v38, s[60:63], s34 offen sc1
    s_waitcnt lgkmcnt(0)
    buffer_store_dwordx4 v[24:27], v38, s[60:63], s35 offen sc1
    v_lshrrev_b32 v4, 5, v2
    v_bfe_u32 v3, v2, 2, 2
    v_lshl_add_u32 v5, v4, 2, v3
    v_lshlrev_b32 v5, 8, v5
    v_bfe_u32 v6, v2, 4, 1
    v_lshl_add_u32 v5, v6, 5, v5
    v_and_b32 v6, 3, v2
    v_lshl_add_u32 v5, v6, 3, v5
    v_xor_b32 v6, s23, v3
    v_lshl_add_u32 v8, v6, 6, v5
    s_mov_b32 s33, 0
    s_xor_b32 s37, s46, 1
    s_lshl_b32 s37, s37, 1
    v_xor_b32 v7, s37, v3
    v_xor_b32 v6, 0, v7
    v_lshl_add_u32 v9, v6, 6, v5
    v_xor_b32 v6, 1, v7
    v_lshl_add_u32 v10, v6, 6, v5
    v_xor_b32 v6, 2, v7
    v_lshl_add_u32 v11, v6, 6, v5
    v_xor_b32 v6, 3, v7
    v_lshl_add_u32 v12, v6, 6, v5
    v_lshlrev_b32 v18, 7, v2
    v_mov_b32 v19, v3
    s_waitcnt vmcnt(0)
    s_barrier
    s_cmp_lg_u32 s22, 0
    s_cbranch_scc1 C_nf2
    s_lshr_b32 s28, s2, 2
    s_lshl_b32 s28, s28, 7
    s_and_b32 s32, s2, 3
    s_lshl_b32 s32, s32, 2
    s_add_u32 s28, s28, s32
    s_add_u32 s28, s28, 0x50000
    v_mul_u32_u24 v1, 8320, v2
    v_mov_b32 v3, s42
    s_mov_b64 exec, 15
    buffer_store_dword v3, v1, s[60:63], s28 offen sc1
    s_mov_b64 exec, -1
    s_nop 1
    v_mov_b32 v3, v19
C_nf2:
    v_mov_b32 v24, 0
    v_mov_b32 v25, 0
    v_mov_b32 v26, 0
    v_mov_b32 v27, 0
    v_mov_b32 v28, 0
    v_mov_b32 v29, 0
    v_mov_b32 v30, 0
    v_mov_b32 v31, 0
    v_mov_b32 v32, 0
    v_mov_b32 v33, 0
    v_mov_b32 v34, 0
    v_mov_b32 v35, 0
    v_mov_b32 v36, 0
    v_mov_b32 v37, 0
    v_mov_b32 v38, 0
    v_mov_b32 v39, 0
    v_mov_b32 v40, 0
    v_mov_b32 v41, 0
    v_mov_b32 v42, 0
    v_mov_b32 v43, 0
    v_mov_b32 v44, 0
    v_mov_b32 v45, 0
    v_mov_b32 v46, 0
    v_mov_b32 v47, 0
    v_mov_b32 v48, 0
    v_mov_b32 v49, 0
    v_mov_b32 v50, 0
    v_mov_b32 v51, 0
    v_mov_b32 v52, 0
    v_mov_b32 v53, 0
    v_mov_b32 v54, 0
    v_mov_b32 v55, 0
    v_mov_b32 v56, 0
    v_mov_b32 v57, 0
    v_mov_b32 v58, 0
    v_mov_b32 v59, 0
    v_mov_b32 v60, 0
    v_mov_b32 v61, 0
    v_mov_b32 v62, 0
    v_mov_b32 v63, 0
    v_mov_b32 v64, 0
    v_mov_b32 v65, 0
    v_mov_b32 v66, 0
    v_mov_b32 v67, 0
    v_mov_b32 v68, 0
    v_mov_b32 v69, 0
    v_mov_b32 v70, 0
    v_mov_b32 v71, 0
    v_mov_b32 v72, 0
    v_mov_b32 v73, 0
    v_mov_b32 v74, 0
    v_mov_b32 v75, 0
    v_mov_b32 v76, 0
    v_mov_b32 v77, 0
    v_mov_b32 v78, 0
    v_mov_b32 v79, 0
    v_mov_b32 v80, 0
    v_mov_b32 v81, 0
    v_mov_b32 v82, 0
    v_mov_b32 v83, 0
    v_mov_b32 v84, 0
    v_mov_b32 v85, 0
    v_mov_b32 v86, 0
    v_mov_b32 v87, 0
    v_mov_b32 v88, 0
    v_mov_b32 v89, 0
    v_mov_b32 v90, 0
    v_mov_b32 v91, 0
    v_mov_b32 v92, 0
    v_mov_b32 v93, 0
    v_mov_b32 v94, 0
    v_mov_b32 v95, 0
    v_mov_b32 v96, 0
    v_mov_b32 v97, 0
    v_mov_b32 v98, 0
    v_mov_b32 v99, 0
    v_mov_b32 v100, 0
    v_mov_b32 v101, 0
    v_mov_b32 v102, 0
    v_mov_b32 v103, 0
    v_mov_b32 v104, 0
    v_mov_b32 v105, 0
    v_mov_b32 v106, 0
    v_mov_b32 v107, 0
    v_mov_b32 v108, 0
    v_mov_b32 v109, 0
    v_mov_b32 v110, 0
    v_mov_b32 v111, 0
    v_mov_b32 v112, 0
    v_mov_b32 v113, 0
    v_mov_b32 v114, 0
    v_mov_b32 v115, 0
    v_mov_b32 v116, 0
    v_mov_b32 v117, 0
    v_mov_b32 v118, 0
    v_mov_b32 v119, 0
    v_mov_b32 v120, 0
    v_mov_b32 v121, 0
    v_mov_b32 v122, 0
    v_mov_b32 v123, 0
    v_mov_b32 v124, 0
    v_mov_b32 v125, 0
    v_mov_b32 v126, 0
    v_mov_b32 v127, 0
    v_mov_b32 v128, 0
    v_mov_b32 v129, 0
    v_mov_b32 v130, 0
    v_mov_b32 v131, 0
    v_mov_b32 v132, 0
    v_mov_b32 v133, 0
    v_mov_b32 v134, 0
    v_mov_b32 v135, 0
    v_mov_b32 v136, 0
    v_mov_b32 v137, 0
    v_mov_b32 v138, 0
    v_mov_b32 v139, 0
    v_mov_b32 v140, 0
    v_mov_b32 v141, 0
    v_mov_b32 v142, 0
    v_mov_b32 v143, 0
    v_mov_b32 v144, 0
    v_mov_b32 v145, 0
    v_mov_b32 v146, 0
    v_mov_b32 v147, 0
    v_mov_b32 v148, 0
    v_mov_b32 v149, 0
    v_mov_b32 v150, 0
    v_mov_b32 v151, 0
    s_lshl_b32 s26, s23, 7
    v_lshl_add_u32 v20, v4, 4, s26
    v_add_u32 v20, 147456, v20
    v_and_b32 v21, 31, v2
    v_lshlrev_b32 v21, 2, v21
    v_add_u32 v21, 148480, v21
    s_lshl_b32 s26, s37, 7
    v_add_u32 v21, s26, v21
    v_xor_b32 v22, 128, v21
    v_xor_b32 v23, 256, v21
    v_xor_b32 v19, 384, v21
    s_lshl_b32 s26, s24, 2
    s_mul_i32 s26, s26, 114688
    s_lshl_b32 s5, s25, 3
    s_lshl_b32 s6, s23, 1
    s_add_u32 s5, s5, s6
    s_lshl_b32 s5, s5, 10
    s_add_u32 s26, s26, s5
    s_add_u32 s26, s26, 0x1000000
    s_mul_i32 s4, s37, 114688
    s_add_u32 s4, s4, s26
    s_xor_b32 s5, s37, 1
    s_mul_i32 s5, s5, 114688
    s_add_u32 s5, s5, s26
    s_xor_b32 s6, s37, 2
    s_mul_i32 s6, s6, 114688
    s_add_u32 s6, s6, s26
    s_xor_b32 s7, s37, 3
    s_mul_i32 s7, s7, 114688
    s_add_u32 s7, s7, s26
    v_lshlrev_b32 v6, 4, v2
    s_add_u32 s28, s40, 0x50000
    s_cmp_lg_u32 s22, 0
    s_cbranch_scc1 C_f2_got
    s_mov_b32 s36, 0x40000
C_f2_poll:
    buffer_load_dwordx4 v[152:155], v18, s[60:63], s28 offen sc1
    s_waitcnt vmcnt(0)
    v_xor_b32 v152, s42, v152
    v_xor_b32 v153, s42, v153
    v_xor_b32 v154, s42, v154
    v_xor_b32 v155, s42, v155
    v_or3_b32 v152, v152, v153, v154
    v_or_b32 v152, v152, v155
    v_cmp_eq_u32 vcc, 0, v152
    s_nop 3
    s_cmp_eq_u64 vcc, exec
    s_cbranch_scc1 C_f2_got
    s_sub_u32 s36, s36, 1
    s_cmp_eq_u32 s36, 0
    s_cbranch_scc1 C_f2_got
    s_sleep 1
    s_branch C_f2_poll
C_f2_got:
    s_barrier
    v_add_u32 v13, s33, v8
    v_add_u32 v14, s33, v9
    v_add_u32 v15, s33, v10
    v_add_u32 v16, s33, v11
    v_add_u32 v17, s33, v12
    s_add_u32 s33, s33, 24576
    s_cmp_eq_u32 s33, 147456
    s_cselect_b32 s33, 0, s33
    s_barrier
    ds_read_b64_tr_b16 v[160:161], v14 offset:0
    ds_read_b64_tr_b16 v[162:163], v14 offset:2048
    ds_read_b64_tr_b16 v[152:153], v13 offset:8192
    ds_read_b64_tr_b16 v[154:155], v13 offset:10240
    ds_read_b64_tr_b16 v[156:157], v13 offset:16384
    ds_read_b64_tr_b16 v[158:159], v13 offset:18432
    ds_read_b64_tr_b16 v[164:165], v15 offset:0
    ds_read_b64_tr_b16 v[166:167], v15 offset:2048
    ds_read_b64_tr_b16 v[168:169], v16 offset:0
    ds_read_b64_tr_b16 v[170:171], v16 offset:2048
    ds_read_b64_tr_b16 v[172:173], v17 offset:0
    ds_read_b64_tr_b16 v[174:175], v17 offset:2048
    ds_read_b64_tr_b16 v[184:185], v14 offset:4096
    ds_read_b64_tr_b16 v[186:187], v14 offset:6144
    ds_read_b64_tr_b16 v[176:177], v13 offset:12288
    ds_read_b64_tr_b16 v[178:179], v13 offset:14336
    ds_read_b64_tr_b16 v[180:181], v13 offset:20480
    ds_read_b64_tr_b16 v[182:183], v13 offset:22528
    ds_read_b64_tr_b16 v[188:189], v15 offset:4096
    ds_read_b64_tr_b16 v[190:191], v15 offset:6144
    ds_read_b64_tr_b16 v[192:193], v16 offset:4096
    ds_read_b64_tr_b16 v[194:195], v16 offset:6144
    ds_read_b64_tr_b16 v[196:197], v17 offset:4096
    ds_read_b64_tr_b16 v[198:199], v17 offset:6144
    s_mov_b32 s36, 7
C_loop3:
    s_waitcnt lgkmcnt(15)
    v_mfma_f32_32x32x16_bf16 v[24:39], v[152:155], v[160:163], v[24:39]
    v_add_u32 v13, s33, v8
    v_add_u32 v14, s33, v9
    v_add_u32 v15, s33, v10
    v_add_u32 v16, s33, v11
    v_mfma_f32_32x32x16_bf16 v[88:103], v[156:159], v[160:163], v[88:103]
    v_add_u32 v17, s33, v12
    s_add_u32 s33, s33, 24576
    s_cmp_eq_u32 s33, 147456
    s_cselect_b32 s33, 0, s33
    v_mfma_f32_32x32x16_bf16 v[40:55], v[152:155], v[164:167], v[40:55]
    s_waitcnt lgkmcnt(0)
    s_barrier
    v_mfma_f32_32x32x16_bf16 v[104:119], v[156:159], v[164:167], v[104:119]
    ds_read_b64_tr_b16 v[208:209], v14 offset:0
    ds_read_b64_tr_b16 v[210:211], v14 offset:2048
    v_mfma_f32_32x32x16_bf16 v[56:71], v[152:155], v[168:171], v[56:71]
    ds_read_b64_tr_b16 v[200:201], v13 offset:8192
    ds_read_b64_tr_b16 v[202:203], v13 offset:10240
    v_mfma_f32_32x32x16_bf16 v[120:135], v[156:159], v[168:171], v[120:135]
    ds_read_b64_tr_b16 v[204:205], v13 offset:16384
    ds_read_b64_tr_b16 v[206:207], v13 offset:18432
    v_mfma_f32_32x32x16_bf16 v[72:87], v[152:155], v[172:175], v[72:87]
    ds_read_b64_tr_b16 v[212:213], v15 offset:0
    ds_read_b64_tr_b16 v[214:215], v15 offset:2048
    v_mfma_f32_32x32x16_bf16 v[136:151], v[156:159], v[172:175], v[136:151]
    ds_read_b64_tr_b16 v[216:217], v16 offset:0
    ds_read_b64_tr_b16 v[218:219], v16 offset:2048
    v_mfma_f32_32x32x16_bf16 v[24:39], v[176:179], v[184:187], v[24:39]
    ds_read_b64_tr_b16 v[220:221], v17 offset:0
    ds_read_b64_tr_b16 v[222:223], v17 offset:2048
    v_mfma_f32_32x32x16_bf16 v[88:103], v[180:183], v[184:187], v[88:103]
    ds_read_b64_tr_b16 v[232:233], v14 offset:4096
    ds_read_b64_tr_b16 v[234:235], v14 offset:6144
    v_mfma_f32_32x32x16_bf16 v[40:55], v[176:179], v[188:191], v[40:55]
    ds_read_b64_tr_b16 v[224:225], v13 offset:12288
    ds_read_b64_tr_b16 v[226:227], v13 offset:14336
    v_mfma_f32_32x32x16_bf16 v[104:119], v[180:183], v[188:191], v[104:119]
    ds_read_b64_tr_b16 v[228:229], v13 offset:20480
    ds_read_b64_tr_b16 v[230:231], v13 offset:22528
    v_mfma_f32_32x32x16_bf16 v[56:71], v[176:179], v[192:195], v[56:71]
    ds_read_b64_tr_b16 v[236:237], v15 offset:4096
    ds_read_b64_tr_b16 v[238:239], v15 offset:6144
    v_mfma_f32_32x32x16_bf16 v[120:135], v[180:183], v[192:195], v[120:135]
    ds_read_b64_tr_b16 v[240:241], v16 offset:4096
    ds_read_b64_tr_b16 v[242:243], v16 offset:6144
    v_mfma_f32_32x32x16_bf16 v[72:87], v[176:179], v[196:199], v[72:87]
    ds_read_b64_tr_b16 v[244:245], v17 offset:4096
    ds_read_b64_tr_b16 v[246:247], v17 offset:6144
    v_mfma_f32_32x32x16_bf16 v[136:151], v[180:183], v[196:199], v[136:151]
    s_cmp_eq_u32 s36, 1
    s_cbranch_scc1 C_last
    s_waitcnt lgkmcnt(15)
    v_mfma_f32_32x32x16_bf16 v[24:39], v[200:203], v[208:211], v[24:39]
    v_add_u32 v13, s33, v8
    v_add_u32 v14, s33, v9
    v_add_u32 v15, s33, v10
    v_add_u32 v16, s33, v11
    v_mfma_f32_32x32x16_bf16 v[88:103], v[204:207], v[208:211], v[88:103]
    v_add_u32 v17, s33, v12
    s_add_u32 s33, s33, 24576
    s_cmp_eq_u32 s33, 147456
    s_cselect_b32 s33, 0, s33
    v_mfma_f32_32x32x16_bf16 v[40:55], v[200:203], v[212:215], v[40:55]
    ds_read_b64_tr_b16 v[160:161], v14 offset:0
    ds_read_b64_tr_b16 v[162:163], v14 offset:2048
    v_mfma_f32_32x32x16_bf16 v[104:119], v[204:207], v[212:215], v[104:119]
    ds_read_b64_tr_b16 v[152:153], v13 offset:8192
    ds_read_b64_tr_b16 v[154:155], v13 offset:10240
    s_waitcnt lgkmcnt(15)
    v_mfma_f32_32x32x16_bf16 v[56:71], v[200:203], v[216:219], v[56:71]
    ds_read_b64_tr_b16 v[156:157], v13 offset:16384
    ds_read_b64_tr_b16 v[158:159], v13 offset:18432
    v_mfma_f32_32x32x16_bf16 v[120:135], v[204:207], v[216:219], v[120:135]
    ds_read_b64_tr_b16 v[164:165], v15 offset:0
    ds_read_b64_tr_b16 v[166:167], v15 offset:2048
    v_mfma_f32_32x32x16_bf16 v[72:87], v[200:203], v[220:223], v[72:87]
    ds_read_b64_tr_b16 v[168:169], v16 offset:0
    ds_read_b64_tr_b16 v[170:171], v16 offset:2048
    v_mfma_f32_32x32x16_bf16 v[136:151], v[204:207], v[220:223], v[136:151]
    ds_read_b64_tr_b16 v[172:173], v17 offset:0
    ds_read_b64_tr_b16 v[174:175], v17 offset:2048
    s_waitcnt lgkmcnt(15)
    v_mfma_f32_32x32x16_bf16 v[24:39], v[224:227], v[232:235], v[24:39]
    ds_read_b64_tr_b16 v[184:185], v14 offset:4096
    ds_read_b64_tr_b16 v[186:187], v14 offset:6144
    v_mfma_f32_32x32x16_bf16 v[88:103], v[228:231], v[232:235], v[88:103]
    ds_read_b64_tr_b16 v[176:177], v13 offset:12288
    ds_read_b64_tr_b16 v[178:179], v13 offset:14336
    v_mfma_f32_32x32x16_bf16 v[40:55], v[224:227], v[236:239], v[40:55]
    ds_read_b64_tr_b16 v[180:181], v13 offset:20480
    ds_read_b64_tr_b16 v[182:183], v13 offset:22528
    v_mfma_f32_32x32x16_bf16 v[104:119], v[228:231], v[236:239], v[104:119]
    ds_read_b64_tr_b16 v[188:189], v15 offset:4096
    ds_read_b64_tr_b16 v[190:191], v15 offset:6144
    s_waitcnt lgkmcnt(15)
    v_mfma_f32_32x32x16_bf16 v[56:71], v[224:227], v[240:243], v[56:71]
    ds_read_b64_tr_b16 v[192:193], v16 offset:4096
    ds_read_b64_tr_b16 v[194:195], v16 offset:6144
    v_mfma_f32_32x32x16_bf16 v[120:135], v[228:231], v[240:243], v[120:135]
    ds_read_b64_tr_b16 v[196:197], v17 offset:4096
    ds_read_b64_tr_b16 v[198:199], v17 offset:6144
    v_mfma_f32_32x32x16_bf16 v[72:87], v[224:227], v[244:247], v[72:87]
    v_mfma_f32_32x32x16_bf16 v[136:151], v[228:231], v[244:247], v[136:151]
    s_sub_u32 s36, s36, 1
    s_branch C_loop3
C_last:
    s_waitcnt lgkmcnt(15)
    v_mfma_f32_32x32x16_bf16 v[24:39], v[200:203], v[208:211], v[24:39]
    v_mfma_f32_32x32x16_bf16 v[88:103], v[204:207], v[208:211], v[88:103]
    ds_read_b32 v184, v21
    ds_read_b32 v186, v22
    ds_read_b32 v188, v23
    ds_read_b32 v190, v19
    ds_read_b128 v[152:155], v20 offset:0
    ds_read_b128 v[168:171], v20 offset:512
    s_waitcnt lgkmcnt(14)
    v_mfma_f32_32x32x16_bf16 v[24:39], v[224:227], v[232:235], v[24:39]
    s_waitcnt lgkmcnt(12)
    v_mfma_f32_32x32x16_bf16 v[88:103], v[228:231], v[232:235], v[88:103]
    ds_read_b128 v[156:159], v20 offset:32
    ds_read_b128 v[172:175], v20 offset:544
    ds_read_b128 v[160:163], v20 offset:64
    ds_read_b128 v[176:179], v20 offset:576
    ds_read_b128 v[164:167], v20 offset:96
    ds_read_b128 v[180:183], v20 offset:608
    v_mfma_f32_32x32x16_bf16 v[40:55], v[200:203], v[212:215], v[40:55]
    v_mfma_f32_32x32x16_bf16 v[104:119], v[204:207], v[212:215], v[104:119]
    s_waitcnt lgkmcnt(15)
    v_mfma_f32_32x32x16_bf16 v[40:55], v[224:227], v[236:239], v[40:55]
    v_mfma_f32_32x32x16_bf16 v[104:119], v[228:231], v[236:239], v[104:119]
    s_waitcnt lgkmcnt(0)
    s_barrier
    s_nop 5
    v_mfma_f32_32x32x16_bf16 v[56:71], v[200:203], v[216:219], v[56:71]
    v_pk_fma_f32 v[24:25], v[152:153], v[184:185], v[24:25] op_sel_hi:[1,0,1] neg_lo:[0,1,0] neg_hi:[0,1,0]
    v_pk_fma_f32 v[88:89], v[168:169], v[184:185], v[88:89] op_sel_hi:[1,0,1] neg_lo:[0,1,0] neg_hi:[0,1,0]
    v_pk_fma_f32 v[26:27], v[154:155], v[184:185], v[26:27] op_sel_hi:[1,0,1] neg_lo:[0,1,0] neg_hi:[0,1,0]
    v_pk_fma_f32 v[90:91], v[170:171], v[184:185], v[90:91] op_sel_hi:[1,0,1] neg_lo:[0,1,0] neg_hi:[0,1,0]
    v_max_f32 v24, 0, v24
    v_max_f32 v25, 0, v25
    v_max_f32 v26, 0, v26
    v_max_f32 v27, 0, v27
    v_pk_mul_f32 v[24:25], v[24:25], v[88:89]
    v_pk_mul_f32 v[26:27], v[26:27], v[90:91]
    v_cvt_pk_bf16_f32 v248, v24, v25
    v_cvt_pk_bf16_f32 v249, v26, v27
    v_mfma_f32_32x32x16_bf16 v[120:135], v[204:207], v[216:219], v[120:135]
    v_pk_fma_f32 v[28:29], v[156:157], v[184:185], v[28:29] op_sel_hi:[1,0,1] neg_lo:[0,1,0] neg_hi:[0,1,0]
    v_pk_fma_f32 v[92:93], v[172:173], v[184:185], v[92:93] op_sel_hi:[1,0,1] neg_lo:[0,1,0] neg_hi:[0,1,0]
    v_pk_fma_f32 v[30:31], v[158:159], v[184:185], v[30:31] op_sel_hi:[1,0,1] neg_lo:[0,1,0] neg_hi:[0,1,0]
    v_pk_fma_f32 v[94:95], v[174:175], v[184:185], v[94:95] op_sel_hi:[1,0,1] neg_lo:[0,1,0] neg_hi:[0,1,0]
    v_max_f32 v28, 0, v28
    v_max_f32 v29, 0, v29
    v_max_f32 v30, 0, v30
    v_max_f32 v31, 0, v31
    v_pk_mul_f32 v[28:29], v[28:29], v[92:93]
    v_pk_mul_f32 v[30:31], v[30:31], v[94:95]
    v_cvt_pk_bf16_f32 v250, v28, v29
    v_cvt_pk_bf16_f32 v251, v30, v31
    buffer_store_dwordx4 v[248:251], v6, s[60:63], s4 offen offset:0 sc1
    v_mfma_f32_32x32x16_bf16 v[56:71], v[224:227], v[240:243], v[56:71]
    v_pk_fma_f32 v[32:33], v[160:161], v[184:185], v[32:33] op_sel_hi:[1,0,1] neg_lo:[0,1,0] neg_hi:[0,1,0]
    v_pk_fma_f32 v[96:97], v[176:177], v[184:185], v[96:97] op_sel_hi:[1,0,1] neg_lo:[0,1,0] neg_hi:[0,1,0]
    v_pk_fma_f32 v[34:35], v[162:163], v[184:185], v[34:35] op_sel_hi:[1,0,1] neg_lo:[0,1,0] neg_hi:[0,1,0]
    v_pk_fma_f32 v[98:99], v[178:179], v[184:185], v[98:99] op_sel_hi:[1,0,1] neg_lo:[0,1,0] neg_hi:[0,1,0]
    v_max_f32 v32, 0, v32
    v_max_f32 v33, 0, v33
    v_max_f32 v34, 0, v34
    v_max_f32 v35, 0, v35
    v_pk_mul_f32 v[32:33], v[32:33], v[96:97]
    v_pk_mul_f32 v[34:35], v[34:35], v[98:99]
    v_cvt_pk_bf16_f32 v252, v32, v33
    v_cvt_pk_bf16_f32 v253, v34, v35
    v_mfma_f32_32x32x16_bf16 v[120:135], v[228:231], v[240:243], v[120:135]
    v_pk_fma_f32 v[36:37], v[164:165], v[184:185], v[36:37] op_sel_hi:[1,0,1] neg_lo:[0,1,0] neg_hi:[0,1,0]
    v_pk_fma_f32 v[100:101], v[180:181], v[184:185], v[100:101] op_sel_hi:[1,0,1] neg_lo:[0,1,0] neg_hi:[0,1,0]
    v_pk_fma_f32 v[38:39], v[166:167], v[184:185], v[38:39] op_sel_hi:[1,0,1] neg_lo:[0,1,0] neg_hi:[0,1,0]
    v_pk_fma_f32 v[102:103], v[182:183], v[184:185], v[102:103] op_sel_hi:[1,0,1] neg_lo:[0,1,0] neg_hi:[0,1,0]
    v_max_f32 v36, 0, v36
    v_max_f32 v37, 0, v37
    v_max_f32 v38, 0, v38
    v_max_f32 v39, 0, v39
    v_pk_mul_f32 v[36:37], v[36:37], v[100:101]
    v_pk_mul_f32 v[38:39], v[38:39], v[102:103]
    v_cvt_pk_bf16_f32 v254, v36, v37
    v_cvt_pk_bf16_f32 v255, v38, v39
    buffer_store_dwordx4 v[252:255], v6, s[60:63], s4 offen offset:1024 sc1
    v_mfma_f32_32x32x16_bf16 v[72:87], v[200:203], v[220:223], v[72:87]
    v_pk_fma_f32 v[40:41], v[152:153], v[186:187], v[40:41] op_sel_hi:[1,0,1] neg_lo:[0,1,0] neg_hi:[0,1,0]
    v_pk_fma_f32 v[104:105], v[168:169], v[186:187], v[104:105] op_sel_hi:[1,0,1] neg_lo:[0,1,0] neg_hi:[0,1,0]
    v_pk_fma_f32 v[42:43], v[154:155], v[186:187], v[42:43] op_sel_hi:[1,0,1] neg_lo:[0,1,0] neg_hi:[0,1,0]
    v_pk_fma_f32 v[106:107], v[170:171], v[186:187], v[106:107] op_sel_hi:[1,0,1] neg_lo:[0,1,0] neg_hi:[0,1,0]
    v_max_f32 v40, 0, v40
    v_max_f32 v41, 0, v41
    v_max_f32 v42, 0, v42
    v_max_f32 v43, 0, v43
    v_pk_mul_f32 v[40:41], v[40:41], v[104:105]
    v_pk_mul_f32 v[42:43], v[42:43], v[106:107]
    v_cvt_pk_bf16_f32 v248, v40, v41
    v_cvt_pk_bf16_f32 v249, v42, v43
    v_mfma_f32_32x32x16_bf16 v[136:151], v[204:207], v[220:223], v[136:151]
    v_pk_fma_f32 v[44:45], v[156:157], v[186:187], v[44:45] op_sel_hi:[1,0,1] neg_lo:[0,1,0] neg_hi:[0,1,0]
    v_pk_fma_f32 v[108:109], v[172:173], v[186:187], v[108:109] op_sel_hi:[1,0,1] neg_lo:[0,1,0] neg_hi:[0,1,0]
    v_pk_fma_f32 v[46:47], v[158:159], v[186:187], v[46:47] op_sel_hi:[1,0,1] neg_lo:[0,1,0] neg_hi:[0,1,0]
    v_pk_fma_f32 v[110:111], v[174:175], v[186:187], v[110:111] op_sel_hi:[1,0,1] neg_lo:[0,1,0] neg_hi:[0,1,0]
    v_max_f32 v44, 0, v44
    v_max_f32 v45, 0, v45
    v_max_f32 v46, 0, v46
    v_max_f32 v47, 0, v47
    v_pk_mul_f32 v[44:45], v[44:45], v[108:109]
    v_pk_mul_f32 v[46:47], v[46:47], v[110:111]
    v_cvt_pk_bf16_f32 v250, v44, v45
    v_cvt_pk_bf16_f32 v251, v46, v47
    buffer_store_dwordx4 v[248:251], v6, s[60:63], s5 offen offset:0 sc1
    v_mfma_f32_32x32x16_bf16 v[72:87], v[224:227], v[244:247], v[72:87]
    v_pk_fma_f32 v[48:49], v[160:161], v[186:187], v[48:49] op_sel_hi:[1,0,1] neg_lo:[0,1,0] neg_hi:[0,1,0]
    v_pk_fma_f32 v[112:113], v[176:177], v[186:187], v[112:113] op_sel_hi:[1,0,1] neg_lo:[0,1,0] neg_hi:[0,1,0]
    v_pk_fma_f32 v[50:51], v[162:163], v[186:187], v[50:51] op_sel_hi:[1,0,1] neg_lo:[0,1,0] neg_hi:[0,1,0]
    v_pk_fma_f32 v[114:115], v[178:179], v[186:187], v[114:115] op_sel_hi:[1,0,1] neg_lo:[0,1,0] neg_hi:[0,1,0]
    v_max_f32 v48, 0, v48
    v_max_f32 v49, 0, v49
    v_max_f32 v50, 0, v50
    v_max_f32 v51, 0, v51
    v_pk_mul_f32 v[48:49], v[48:49], v[112:113]
    v_pk_mul_f32 v[50:51], v[50:51], v[114:115]
    v_cvt_pk_bf16_f32 v252, v48, v49
    v_cvt_pk_bf16_f32 v253, v50, v51
    v_mfma_f32_32x32x16_bf16 v[136:151], v[228:231], v[244:247], v[136:151]
    v_pk_fma_f32 v[52:53], v[164:165], v[186:187], v[52:53] op_sel_hi:[1,0,1] neg_lo:[0,1,0] neg_hi:[0,1,0]
    v_pk_fma_f32 v[116:117], v[180:181], v[186:187], v[116:117] op_sel_hi:[1,0,1] neg_lo:[0,1,0] neg_hi:[0,1,0]
    v_pk_fma_f32 v[54:55], v[166:167], v[186:187], v[54:55] op_sel_hi:[1,0,1] neg_lo:[0,1,0] neg_hi:[0,1,0]
    v_pk_fma_f32 v[118:119], v[182:183], v[186:187], v[118:119] op_sel_hi:[1,0,1] neg_lo:[0,1,0] neg_hi:[0,1,0]
    v_max_f32 v52, 0, v52
    v_max_f32 v53, 0, v53
    v_max_f32 v54, 0, v54
    v_max_f32 v55, 0, v55
    v_pk_mul_f32 v[52:53], v[52:53], v[116:117]
    v_pk_mul_f32 v[54:55], v[54:55], v[118:119]
    v_cvt_pk_bf16_f32 v254, v52, v53
    v_cvt_pk_bf16_f32 v255, v54, v55
    buffer_store_dwordx4 v[252:255], v6, s[60:63], s5 offen offset:1024 sc1
    v_pk_fma_f32 v[56:57], v[152:153], v[188:189], v[56:57] op_sel_hi:[1,0,1] neg_lo:[0,1,0] neg_hi:[0,1,0]
    v_pk_fma_f32 v[120:121], v[168:169], v[188:189], v[120:121] op_sel_hi:[1,0,1] neg_lo:[0,1,0] neg_hi:[0,1,0]
    v_pk_fma_f32 v[58:59], v[154:155], v[188:189], v[58:59] op_sel_hi:[1,0,1] neg_lo:[0,1,0] neg_hi:[0,1,0]
    v_pk_fma_f32 v[122:123], v[170:171], v[188:189], v[122:123] op_sel_hi:[1,0,1] neg_lo:[0,1,0] neg_hi:[0,1,0]
    v_max_f32 v56, 0, v56
    v_max_f32 v57, 0, v57
    v_max_f32 v58, 0, v58
    v_max_f32 v59, 0, v59
    v_pk_mul_f32 v[56:57], v[56:57], v[120:121]
    v_pk_mul_f32 v[58:59], v[58:59], v[122:123]
    v_cvt_pk_bf16_f32 v192, v56, v57
    v_cvt_pk_bf16_f32 v193, v58, v59
    v_pk_fma_f32 v[60:61], v[156:157], v[188:189], v[60:61] op_sel_hi:[1,0,1] neg_lo:[0,1,0] neg_hi:[0,1,0]
    v_pk_fma_f32 v[124:125], v[172:173], v[188:189], v[124:125] op_sel_hi:[1,0,1] neg_lo:[0,1,0] neg_hi:[0,1,0]
    v_pk_fma_f32 v[62:63], v[158:159], v[188:189], v[62:63] op_sel_hi:[1,0,1] neg_lo:[0,1,0] neg_hi:[0,1,0]
    v_pk_fma_f32 v[126:127], v[174:175], v[188:189], v[126:127] op_sel_hi:[1,0,1] neg_lo:[0,1,0] neg_hi:[0,1,0]
    v_max_f32 v60, 0, v60
    v_max_f32 v61, 0, v61
    v_max_f32 v62, 0, v62
    v_max_f32 v63, 0, v63
    v_pk_mul_f32 v[60:61], v[60:61], v[124:125]
    v_pk_mul_f32 v[62:63], v[62:63], v[126:127]
    v_cvt_pk_bf16_f32 v194, v60, v61
    v_cvt_pk_bf16_f32 v195, v62, v63
    buffer_store_dwordx4 v[192:195], v6, s[60:63], s6 offen offset:0 sc1
    v_pk_fma_f32 v[64:65], v[160:161], v[188:189], v[64:65] op_sel_hi:[1,0,1] neg_lo:[0,1,0] neg_hi:[0,1,0]
    v_pk_fma_f32 v[128:129], v[176:177], v[188:189], v[128:129] op_sel_hi:[1,0,1] neg_lo:[0,1,0] neg_hi:[0,1,0]
    v_pk_fma_f32 v[66:67], v[162:163], v[188:189], v[66:67] op_sel_hi:[1,0,1] neg_lo:[0,1,0] neg_hi:[0,1,0]
    v_pk_fma_f32 v[130:131], v[178:179], v[188:189], v[130:131] op_sel_hi:[1,0,1] neg_lo:[0,1,0] neg_hi:[0,1,0]
    v_max_f32 v64, 0, v64
    v_max_f32 v65, 0, v65
    v_max_f32 v66, 0, v66
    v_max_f32 v67, 0, v67
    v_pk_mul_f32 v[64:65], v[64:65], v[128:129]
    v_pk_mul_f32 v[66:67], v[66:67], v[130:131]
    v_cvt_pk_bf16_f32 v196, v64, v65
    v_cvt_pk_bf16_f32 v197, v66, v67
    v_pk_fma_f32 v[68:69], v[164:165], v[188:189], v[68:69] op_sel_hi:[1,0,1] neg_lo:[0,1,0] neg_hi:[0,1,0]
    v_pk_fma_f32 v[132:133], v[180:181], v[188:189], v[132:133] op_sel_hi:[1,0,1] neg_lo:[0,1,0] neg_hi:[0,1,0]
    v_pk_fma_f32 v[70:71], v[166:167], v[188:189], v[70:71] op_sel_hi:[1,0,1] neg_lo:[0,1,0] neg_hi:[0,1,0]
    v_pk_fma_f32 v[134:135], v[182:183], v[188:189], v[134:135] op_sel_hi:[1,0,1] neg_lo:[0,1,0] neg_hi:[0,1,0]
    v_max_f32 v68, 0, v68
    v_max_f32 v69, 0, v69
    v_max_f32 v70, 0, v70
    v_max_f32 v71, 0, v71
    v_pk_mul_f32 v[68:69], v[68:69], v[132:133]
    v_pk_mul_f32 v[70:71], v[70:71], v[134:135]
    v_cvt_pk_bf16_f32 v198, v68, v69
    v_cvt_pk_bf16_f32 v199, v70, v71
    buffer_store_dwordx4 v[196:199], v6, s[60:63], s6 offen offset:1024 sc1
    v_pk_fma_f32 v[72:73], v[152:153], v[190:191], v[72:73] op_sel_hi:[1,0,1] neg_lo:[0,1,0] neg_hi:[0,1,0]
    v_pk_fma_f32 v[136:137], v[168:169], v[190:191], v[136:137] op_sel_hi:[1,0,1] neg_lo:[0,1,0] neg_hi:[0,1,0]
    v_pk_fma_f32 v[74:75], v[154:155], v[190:191], v[74:75] op_sel_hi:[1,0,1] neg_lo:[0,1,0] neg_hi:[0,1,0]
    v_pk_fma_f32 v[138:139], v[170:171], v[190:191], v[138:139] op_sel_hi:[1,0,1] neg_lo:[0,1,0] neg_hi:[0,1,0]
    v_max_f32 v72, 0, v72
    v_max_f32 v73, 0, v73
    v_max_f32 v74, 0, v74
    v_max_f32 v75, 0, v75
    v_pk_mul_f32 v[72:73], v[72:73], v[136:137]
    v_pk_mul_f32 v[74:75], v[74:75], v[138:139]
    v_cvt_pk_bf16_f32 v200, v72, v73
    v_cvt_pk_bf16_f32 v201, v74, v75
    v_pk_fma_f32 v[76:77], v[156:157], v[190:191], v[76:77] op_sel_hi:[1,0,1] neg_lo:[0,1,0] neg_hi:[0,1,0]
    v_pk_fma_f32 v[140:141], v[172:173], v[190:191], v[140:141] op_sel_hi:[1,0,1] neg_lo:[0,1,0] neg_hi:[0,1,0]
    v_pk_fma_f32 v[78:79], v[158:159], v[190:191], v[78:79] op_sel_hi:[1,0,1] neg_lo:[0,1,0] neg_hi:[0,1,0]
    v_pk_fma_f32 v[142:143], v[174:175], v[190:191], v[142:143] op_sel_hi:[1,0,1] neg_lo:[0,1,0] neg_hi:[0,1,0]
    v_max_f32 v76, 0, v76
    v_max_f32 v77, 0, v77
    v_max_f32 v78, 0, v78
    v_max_f32 v79, 0, v79
    v_pk_mul_f32 v[76:77], v[76:77], v[140:141]
    v_pk_mul_f32 v[78:79], v[78:79], v[142:143]
    v_cvt_pk_bf16_f32 v202, v76, v77
    v_cvt_pk_bf16_f32 v203, v78, v79
    buffer_store_dwordx4 v[200:203], v6, s[60:63], s7 offen offset:0 sc1
    v_pk_fma_f32 v[80:81], v[160:161], v[190:191], v[80:81] op_sel_hi:[1,0,1] neg_lo:[0,1,0] neg_hi:[0,1,0]
    v_pk_fma_f32 v[144:145], v[176:177], v[190:191], v[144:145] op_sel_hi:[1,0,1] neg_lo:[0,1,0] neg_hi:[0,1,0]
    v_pk_fma_f32 v[82:83], v[162:163], v[190:191], v[82:83] op_sel_hi:[1,0,1] neg_lo:[0,1,0] neg_hi:[0,1,0]
    v_pk_fma_f32 v[146:147], v[178:179], v[190:191], v[146:147] op_sel_hi:[1,0,1] neg_lo:[0,1,0] neg_hi:[0,1,0]
    v_max_f32 v80, 0, v80
    v_max_f32 v81, 0, v81
    v_max_f32 v82, 0, v82
    v_max_f32 v83, 0, v83
    v_pk_mul_f32 v[80:81], v[80:81], v[144:145]
    v_pk_mul_f32 v[82:83], v[82:83], v[146:147]
    v_cvt_pk_bf16_f32 v204, v80, v81
    v_cvt_pk_bf16_f32 v205, v82, v83
    v_pk_fma_f32 v[84:85], v[164:165], v[190:191], v[84:85] op_sel_hi:[1,0,1] neg_lo:[0,1,0] neg_hi:[0,1,0]
    v_pk_fma_f32 v[148:149], v[180:181], v[190:191], v[148:149] op_sel_hi:[1,0,1] neg_lo:[0,1,0] neg_hi:[0,1,0]
    v_pk_fma_f32 v[86:87], v[166:167], v[190:191], v[86:87] op_sel_hi:[1,0,1] neg_lo:[0,1,0] neg_hi:[0,1,0]
    v_pk_fma_f32 v[150:151], v[182:183], v[190:191], v[150:151] op_sel_hi:[1,0,1] neg_lo:[0,1,0] neg_hi:[0,1,0]
    v_max_f32 v84, 0, v84
    v_max_f32 v85, 0, v85
    v_max_f32 v86, 0, v86
    v_max_f32 v87, 0, v87
    v_pk_mul_f32 v[84:85], v[84:85], v[148:149]
    v_pk_mul_f32 v[86:87], v[86:87], v[150:151]
    v_cvt_pk_bf16_f32 v206, v84, v85
    v_cvt_pk_bf16_f32 v207, v86, v87
    buffer_store_dwordx4 v[204:207], v6, s[60:63], s7 offen offset:1024 sc1
    v_lshl_add_u32 v5, v4, 2, v3
    v_lshlrev_b32 v5, 7, v5
    v_bfe_u32 v7, v2, 4, 1
    v_lshl_add_u32 v5, v7, 5, v5
    v_and_b32 v7, 3, v2
    v_lshl_add_u32 v5, v7, 3, v5
    v_lshrrev_b32 v3, 1, v3
    s_and_b32 s26, s23, 1
    s_lshr_b32 s27, s23, 1
    s_lshl_b32 s28, s23, 12
    v_xor_b32 v7, s27, v3
    v_lshl_add_u32 v8, v7, 6, v5
    v_add_u32 v8, s28, v8
    v_xor_b32 v9, 64, v8
    v_add_u32 v10, 0x10000, v8
    v_add_u32 v11, 0x10000, v9
    v_add_u32 v12, 0x20000, v8
    v_add_u32 v13, 0x20000, v9
    v_xor_b32 v7, s26, v3
    v_lshl_add_u32 v14, v7, 6, v5
    s_lshl_b32 s28, s27, 12
    s_add_u32 s28, s28, 149504
    v_add_u32 v14, s28, v14
    s_lshl_b32 s28, s24, 1
    s_add_u32 s28, s28, s46
    s_lshl_b32 s28, s28, 1
    s_add_u32 s28, s28, s26
    s_mul_i32 s29, s28, 28672
    s_mul_i32 s30, s28, 114688
    s_lshl_b32 s28, s47, 7
    s_add_u32 s29, s29, s28
    s_lshl_b32 s28, s27, 6
    s_add_u32 s29, s29, s28
    s_mul_i32 s35, s26, 229376
    s_sub_u32 s35, 114688, s35
    s_lshl_b32 s28, s23, 11
    s_add_u32 s30, s30, s28
    s_add_u32 s38, s30, 0x1000000
    s_add_u32 s39, s25, 1
    s_cmp_eq_u32 s39, 14
    s_cselect_b32 s39, 0, s39
    s_lshl_b32 s39, s39, 13
    s_add_u32 s30, s38, s39
    s_add_u32 s31, s30, s35
    s_lshl_b32 s34, s24, 9
    s_add_u32 s34, s34, 0x70000
    s_and_b32 s28, s25, 3
    s_lshl_b32 s28, s28, 7
    s_lshr_b32 s32, s25, 2
    s_lshl_b32 s32, s32, 2
    s_add_u32 s28, s28, s32
    s_add_u32 s28, s28, s34
    v_mov_b32 v7, s42
    v_mul_u32_u24 v1, 268, v2
    s_cmp_lt_u32 s25, 2
    s_cselect_b32 s32, 3, 1
    s_mov_b32 s33, 0
    v_and_b32 v15, 3, v2
    v_lshlrev_b32 v15, 7, v15
    v_mov_b32 v16, 0
    v_mov_b32 v17, 0
    v_mov_b32 v18, 0
    v_mov_b32 v19, 0
    v_mov_b32 v20, 0
    v_mov_b32 v21, 0
    v_mov_b32 v22, 0
    v_mov_b32 v23, 0
    v_mov_b32 v24, 0
    v_mov_b32 v25, 0
    v_mov_b32 v26, 0
    v_mov_b32 v27, 0
    v_mov_b32 v28, 0
    v_mov_b32 v29, 0
    v_mov_b32 v30, 0
    v_mov_b32 v31, 0
    v_mov_b32 v32, 0
    v_mov_b32 v33, 0
    v_mov_b32 v34, 0
    v_mov_b32 v35, 0
    v_mov_b32 v36, 0
    v_mov_b32 v37, 0
    v_mov_b32 v38, 0
    v_mov_b32 v39, 0
    v_mov_b32 v40, 0
    v_mov_b32 v41, 0
    v_mov_b32 v42, 0
    v_mov_b32 v43, 0
    v_mov_b32 v44, 0
    v_mov_b32 v45, 0
    v_mov_b32 v46, 0
    v_mov_b32 v47, 0
    v_mov_b32 v48, 0
    v_mov_b32 v49, 0
    v_mov_b32 v50, 0
    v_mov_b32 v51, 0
    v_mov_b32 v52, 0
    v_mov_b32 v53, 0
    v_mov_b32 v54, 0
    v_mov_b32 v55, 0
    v_mov_b32 v56, 0
    v_mov_b32 v57, 0
    v_mov_b32 v58, 0
    v_mov_b32 v59, 0
    v_mov_b32 v60, 0
    v_mov_b32 v61, 0
    v_mov_b32 v62, 0
    v_mov_b32 v63, 0
    v_mov_b32 v64, 0
    v_mov_b32 v65, 0
    v_mov_b32 v66, 0
    v_mov_b32 v67, 0
    v_mov_b32 v68, 0
    v_mov_b32 v69, 0
    v_mov_b32 v70, 0
    v_mov_b32 v71, 0
    v_mov_b32 v72, 0
    v_mov_b32 v73, 0
    v_mov_b32 v74, 0
    v_mov_b32 v75, 0
    v_mov_b32 v76, 0
    v_mov_b32 v77, 0
    v_mov_b32 v78, 0
    v_mov_b32 v79, 0
    s_waitcnt vmcnt(0)
    s_barrier
    s_cmp_lg_u32 s23, 0
    s_cbranch_scc1 C_nf4
    s_mov_b64 exec, s[32:33]
    buffer_store_dword v7, v1, s[60:63], s28 offen sc1
    s_mov_b64 exec, -1
C_nf4:
    s_cmp_eq_u32 s26, 0
    s_cbranch_scc1 C_nsw
    v_swap_b32 v192, v200
    v_swap_b32 v193, v201
    v_swap_b32 v194, v202
    v_swap_b32 v195, v203
    v_swap_b32 v196, v204
    v_swap_b32 v197, v205
    v_swap_b32 v198, v206
    v_swap_b32 v199, v207
C_nsw:
    ds_read_b64_tr_b16 v[80:81], v8 offset:0
    ds_read_b64_tr_b16 v[82:83], v8 offset:1024
    ds_read_b64_tr_b16 v[84:85], v9 offset:0
    ds_read_b64_tr_b16 v[86:87], v9 offset:1024
    ds_read_b64_tr_b16 v[88:89], v8 offset:2048
    ds_read_b64_tr_b16 v[90:91], v8 offset:3072
    ds_read_b64_tr_b16 v[92:93], v9 offset:2048
    ds_read_b64_tr_b16 v[94:95], v9 offset:3072
    ds_read_b64_tr_b16 v[96:97], v8 offset:16384
    ds_read_b64_tr_b16 v[98:99], v8 offset:17408
    ds_read_b64_tr_b16 v[100:101], v9 offset:16384
    ds_read_b64_tr_b16 v[102:103], v9 offset:17408
    ds_read_b64_tr_b16 v[104:105], v8 offset:18432
    ds_read_b64_tr_b16 v[106:107], v8 offset:19456
    ds_read_b64_tr_b16 v[108:109], v9 offset:18432
    ds_read_b64_tr_b16 v[110:111], v9 offset:19456
    ds_read_b64_tr_b16 v[112:113], v8 offset:32768
    ds_read_b64_tr_b16 v[114:115], v8 offset:33792
    ds_read_b64_tr_b16 v[116:117], v9 offset:32768
    ds_read_b64_tr_b16 v[118:119], v9 offset:33792
    ds_read_b64_tr_b16 v[120:121], v8 offset:34816
    ds_read_b64_tr_b16 v[122:123], v8 offset:35840
    ds_read_b64_tr_b16 v[124:125], v9 offset:34816
    ds_read_b64_tr_b16 v[126:127], v9 offset:35840
    ds_read_b64_tr_b16 v[128:129], v8 offset:49152
    ds_read_b64_tr_b16 v[130:131], v8 offset:50176
    ds_read_b64_tr_b16 v[132:133], v9 offset:49152
    ds_read_b64_tr_b16 v[134:135], v9 offset:50176
    ds_read_b64_tr_b16 v[136:137], v8 offset:51200
    ds_read_b64_tr_b16 v[138:139], v8 offset:52224
    ds_read_b64_tr_b16 v[140:141], v9 offset:51200
    ds_read_b64_tr_b16 v[142:143], v9 offset:52224
    ds_read_b64_tr_b16 v[144:145], v10 offset:0
    ds_read_b64_tr_b16 v[146:147], v10 offset:1024
    ds_read_b64_tr_b16 v[148:149], v11 offset:0
    ds_read_b64_tr_b16 v[150:151], v11 offset:1024
    ds_read_b64_tr_b16 v[152:153], v10 offset:2048
    ds_read_b64_tr_b16 v[154:155], v10 offset:3072
    ds_read_b64_tr_b16 v[156:157], v11 offset:2048
    ds_read_b64_tr_b16 v[158:159], v11 offset:3072
    s_waitcnt lgkmcnt(15)
    v_mfma_f32_32x32x16_bf16 v[16:31], v[80:83], v[192:195], v[16:31]
    v_mfma_f32_32x32x16_bf16 v[32:47], v[80:83], v[200:203], v[32:47]
    v_mfma_f32_32x32x16_bf16 v[48:63], v[84:87], v[192:195], v[48:63]
    v_mfma_f32_32x32x16_bf16 v[64:79], v[84:87], v[200:203], v[64:79]
    v_mfma_f32_32x32x16_bf16 v[16:31], v[88:91], v[196:199], v[16:31]
    v_mfma_f32_32x32x16_bf16 v[32:47], v[88:91], v[204:207], v[32:47]
    v_mfma_f32_32x32x16_bf16 v[48:63], v[92:95], v[196:199], v[48:63]
    v_mfma_f32_32x32x16_bf16 v[64:79], v[92:95], v[204:207], v[64:79]
    s_waitcnt lgkmcnt(0)
    s_barrier
    ds_read_b64_tr_b16 v[80:81], v10 offset:16384
    ds_read_b64_tr_b16 v[82:83], v10 offset:17408
    ds_read_b64_tr_b16 v[84:85], v11 offset:16384
    ds_read_b64_tr_b16 v[86:87], v11 offset:17408
    ds_read_b64_tr_b16 v[88:89], v10 offset:18432
    ds_read_b64_tr_b16 v[90:91], v10 offset:19456
    ds_read_b64_tr_b16 v[92:93], v11 offset:18432
    ds_read_b64_tr_b16 v[94:95], v11 offset:19456
    s_cmp_lg_u32 s23, 0
    s_cbranch_scc1 C_f4_got
    s_mov_b32 s36, 0x40000
C_f4_poll:
    buffer_load_dwordx4 v[160:163], v15, s[60:63], s34 offen sc1
    s_waitcnt vmcnt(0)
    v_xor_b32 v160, s42, v160
    v_xor_b32 v161, s42, v161
    v_xor_b32 v162, s42, v162
    v_xor_b32 v163, s42, v163
    v_or3_b32 v160, v160, v161, v162
    v_or_b32 v160, v160, v163
    v_cmp_eq_u32 vcc, 0, v160
    s_nop 3
    s_cmp_eq_u64 vcc, exec
    s_cbranch_scc1 C_f4_got
    s_sub_u32 s36, s36, 1
    s_cmp_eq_u32 s36, 0
    s_cbranch_scc1 C_f4_got
    s_sleep 1
    s_branch C_f4_poll
C_f4_got:
    s_barrier
    buffer_load_dwordx4 v[208:211], v6, s[60:63], s30 offen offset:0 sc1
    buffer_load_dwordx4 v[212:215], v6, s[60:63], s31 offen offset:0 sc1
    buffer_load_dwordx4 v[216:219], v6, s[60:63], s30 offen offset:1024 sc1
    buffer_load_dwordx4 v[220:223], v6, s[60:63], s31 offen offset:1024 sc1
    s_add_u32 s39, s39, 8192
    s_cmp_eq_u32 s39, 114688
    s_cselect_b32 s39, 0, s39
    s_add_u32 s30, s38, s39
    s_add_u32 s31, s30, s35
    buffer_load_dwordx4 v[224:227], v6, s[60:63], s30 offen offset:0 sc1
    buffer_load_dwordx4 v[228:231], v6, s[60:63], s31 offen offset:0 sc1
    buffer_load_dwordx4 v[232:235], v6, s[60:63], s30 offen offset:1024 sc1
    buffer_load_dwordx4 v[236:239], v6, s[60:63], s31 offen offset:1024 sc1
    s_add_u32 s39, s39, 8192
    s_cmp_eq_u32 s39, 114688
    s_cselect_b32 s39, 0, s39
    s_add_u32 s30, s38, s39
    s_add_u32 s31, s30, s35
    buffer_load_dwordx4 v[240:243], v6, s[60:63], s30 offen offset:0 sc1
    buffer_load_dwordx4 v[244:247], v6, s[60:63], s31 offen offset:0 sc1
    buffer_load_dwordx4 v[248:251], v6, s[60:63], s30 offen offset:1024 sc1
    buffer_load_dwordx4 v[252:255], v6, s[60:63], s31 offen offset:1024 sc1
    s_add_u32 s39, s39, 8192
    s_cmp_eq_u32 s39, 114688
    s_cselect_b32 s39, 0, s39
    s_add_u32 s30, s38, s39
    s_add_u32 s31, s30, s35
    s_waitcnt vmcnt(10)
    v_mfma_f32_32x32x16_bf16 v[16:31], v[96:99], v[208:211], v[16:31]
    buffer_load_dwordx4 v[160:163], v6, s[60:63], s30 offen offset:0 sc1
    v_mfma_f32_32x32x16_bf16 v[32:47], v[96:99], v[212:215], v[32:47]
    buffer_load_dwordx4 v[164:167], v6, s[60:63], s31 offen offset:0 sc1
    v_mfma_f32_32x32x16_bf16 v[48:63], v[100:103], v[208:211], v[48:63]
    buffer_load_dwordx4 v[168:171], v6, s[60:63], s30 offen offset:1024 sc1
    v_mfma_f32_32x32x16_bf16 v[64:79], v[100:103], v[212:215], v[64:79]
    buffer_load_dwordx4 v[172:175], v6, s[60:63], s31 offen offset:1024 sc1
    s_add_u32 s39, s39, 8192
    s_cmp_eq_u32 s39, 114688
    s_cselect_b32 s39, 0, s39
    s_add_u32 s30, s38, s39
    s_add_u32 s31, s30, s35
    s_waitcnt vmcnt(12)
    v_mfma_f32_32x32x16_bf16 v[16:31], v[104:107], v[216:219], v[16:31]
    buffer_load_dwordx4 v[176:179], v6, s[60:63], s30 offen offset:0 sc1
    v_mfma_f32_32x32x16_bf16 v[32:47], v[104:107], v[220:223], v[32:47]
    buffer_load_dwordx4 v[180:183], v6, s[60:63], s31 offen offset:0 sc1
    v_mfma_f32_32x32x16_bf16 v[48:63], v[108:111], v[216:219], v[48:63]
    buffer_load_dwordx4 v[184:187], v6, s[60:63], s30 offen offset:1024 sc1
    v_mfma_f32_32x32x16_bf16 v[64:79], v[108:111], v[220:223], v[64:79]
    buffer_load_dwordx4 v[188:191], v6, s[60:63], s31 offen offset:1024 sc1
    s_add_u32 s39, s39, 8192
    s_cmp_eq_u32 s39, 114688
    s_cselect_b32 s39, 0, s39
    s_add_u32 s30, s38, s39
    s_add_u32 s31, s30, s35
    ds_read_b64_tr_b16 v[96:97], v10 offset:32768
    ds_read_b64_tr_b16 v[98:99], v10 offset:33792
    ds_read_b64_tr_b16 v[100:101], v11 offset:32768
    ds_read_b64_tr_b16 v[102:103], v11 offset:33792
    ds_read_b64_tr_b16 v[104:105], v10 offset:34816
    ds_read_b64_tr_b16 v[106:107], v10 offset:35840
    ds_read_b64_tr_b16 v[108:109], v11 offset:34816
    ds_read_b64_tr_b16 v[110:111], v11 offset:35840
    s_waitcnt vmcnt(14)
    v_mfma_f32_32x32x16_bf16 v[16:31], v[112:115], v[224:227], v[16:31]
    buffer_load_dwordx4 v[192:195], v6, s[60:63], s30 offen offset:0 sc1
    v_mfma_f32_32x32x16_bf16 v[32:47], v[112:115], v[228:231], v[32:47]
    buffer_load_dwordx4 v[196:199], v6, s[60:63], s31 offen offset:0 sc1
    v_mfma_f32_32x32x16_bf16 v[48:63], v[116:119], v[224:227], v[48:63]
    buffer_load_dwordx4 v[200:203], v6, s[60:63], s30 offen offset:1024 sc1
    v_mfma_f32_32x32x16_bf16 v[64:79], v[116:119], v[228:231], v[64:79]
    buffer_load_dwordx4 v[204:207], v6, s[60:63], s31 offen offset:1024 sc1
    s_add_u32 s39, s39, 8192
    s_cmp_eq_u32 s39, 114688
    s_cselect_b32 s39, 0, s39
    s_add_u32 s30, s38, s39
    s_add_u32 s31, s30, s35
    s_waitcnt vmcnt(16)
    v_mfma_f32_32x32x16_bf16 v[16:31], v[120:123], v[232:235], v[16:31]
    buffer_load_dwordx4 v[208:211], v6, s[60:63], s30 offen offset:0 sc1
    v_mfma_f32_32x32x16_bf16 v[32:47], v[120:123], v[236:239], v[32:47]
    buffer_load_dwordx4 v[212:215], v6, s[60:63], s31 offen offset:0 sc1
    v_mfma_f32_32x32x16_bf16 v[48:63], v[124:127], v[232:235], v[48:63]
    buffer_load_dwordx4 v[216:219], v6, s[60:63], s30 offen offset:1024 sc1
    v_mfma_f32_32x32x16_bf16 v[64:79], v[124:127], v[236:239], v[64:79]
    buffer_load_dwordx4 v[220:223], v6, s[60:63], s31 offen offset:1024 sc1
    s_add_u32 s39, s39, 8192
    s_cmp_eq_u32 s39, 114688
    s_cselect_b32 s39, 0, s39
    s_add_u32 s30, s38, s39
    s_add_u32 s31, s30, s35
    ds_read_b64_tr_b16 v[112:113], v10 offset:49152
    ds_read_b64_tr_b16 v[114:115], v10 offset:50176
    ds_read_b64_tr_b16 v[116:117], v11 offset:49152
    ds_read_b64_tr_b16 v[118:119], v11 offset:50176
    ds_read_b64_tr_b16 v[120:121], v10 offset:51200
    ds_read_b64_tr_b16 v[122:123], v10 offset:52224
    ds_read_b64_tr_b16 v[124:125], v11 offset:51200
    ds_read_b64_tr_b16 v[126:127], v11 offset:52224
    s_waitcnt vmcnt(18)
    v_mfma_f32_32x32x16_bf16 v[16:31], v[128:131], v[240:243], v[16:31]
    buffer_load_dwordx4 v[224:227], v6, s[60:63], s30 offen offset:0 sc1
    v_mfma_f32_32x32x16_bf16 v[32:47], v[128:131], v[244:247], v[32:47]
    buffer_load_dwordx4 v[228:231], v6, s[60:63], s31 offen offset:0 sc1
    v_mfma_f32_32x32x16_bf16 v[48:63], v[132:135], v[240:243], v[48:63]
    buffer_load_dwordx4 v[232:235], v6, s[60:63], s30 offen offset:1024 sc1
    v_mfma_f32_32x32x16_bf16 v[64:79], v[132:135], v[244:247], v[64:79]
    buffer_load_dwordx4 v[236:239], v6, s[60:63], s31 offen offset:1024 sc1
    s_add_u32 s39, s39, 8192
    s_cmp_eq_u32 s39, 114688
    s_cselect_b32 s39, 0, s39
    s_add_u32 s30, s38, s39
    s_add_u32 s31, s30, s35
    s_waitcnt vmcnt(20)
    v_mfma_f32_32x32x16_bf16 v[16:31], v[136:139], v[248:251], v[16:31]
    v_mfma_f32_32x32x16_bf16 v[32:47], v[136:139], v[252:255], v[32:47]
    v_mfma_f32_32x32x16_bf16 v[48:63], v[140:143], v[248:251], v[48:63]
    v_mfma_f32_32x32x16_bf16 v[64:79], v[140:143], v[252:255], v[64:79]
    ds_read_b64_tr_b16 v[128:129], v12 offset:0
    ds_read_b64_tr_b16 v[130:131], v12 offset:1024
    ds_read_b64_tr_b16 v[132:133], v13 offset:0
    ds_read_b64_tr_b16 v[134:135], v13 offset:1024
    ds_read_b64_tr_b16 v[136:137], v12 offset:2048
    ds_read_b64_tr_b16 v[138:139], v12 offset:3072
    ds_read_b64_tr_b16 v[140:141], v13 offset:2048
    ds_read_b64_tr_b16 v[142:143], v13 offset:3072
    s_waitcnt vmcnt(18)
    v_mfma_f32_32x32x16_bf16 v[16:31], v[144:147], v[160:163], v[16:31]
    buffer_load_dwordx4 v[240:243], v6, s[60:63], s30 offen offset:0 sc1
    v_mfma_f32_32x32x16_bf16 v[32:47], v[144:147], v[164:167], v[32:47]
    buffer_load_dwordx4 v[244:247], v6, s[60:63], s31 offen offset:0 sc1
    v_mfma_f32_32x32x16_bf16 v[48:63], v[148:151], v[160:163], v[48:63]
    buffer_load_dwordx4 v[248:251], v6, s[60:63], s30 offen offset:1024 sc1
    v_mfma_f32_32x32x16_bf16 v[64:79], v[148:151], v[164:167], v[64:79]
    buffer_load_dwordx4 v[252:255], v6, s[60:63], s31 offen offset:1024 sc1
    s_add_u32 s39, s39, 8192
    s_cmp_eq_u32 s39, 114688
    s_cselect_b32 s39, 0, s39
    s_add_u32 s30, s38, s39
    s_add_u32 s31, s30, s35
    s_waitcnt vmcnt(20)
    v_mfma_f32_32x32x16_bf16 v[16:31], v[152:155], v[168:171], v[16:31]
    v_mfma_f32_32x32x16_bf16 v[32:47], v[152:155], v[172:175], v[32:47]
    v_mfma_f32_32x32x16_bf16 v[48:63], v[156:159], v[168:171], v[48:63]
    v_mfma_f32_32x32x16_bf16 v[64:79], v[156:159], v[172:175], v[64:79]
    ds_read_b64_tr_b16 v[144:145], v8 offset:0
    ds_read_b64_tr_b16 v[146:147], v8 offset:1024
    ds_read_b64_tr_b16 v[148:149], v9 offset:0
    ds_read_b64_tr_b16 v[150:151], v9 offset:1024
    ds_read_b64_tr_b16 v[152:153], v8 offset:2048
    ds_read_b64_tr_b16 v[154:155], v8 offset:3072
    ds_read_b64_tr_b16 v[156:157], v9 offset:2048
    ds_read_b64_tr_b16 v[158:159], v9 offset:3072
    s_waitcnt vmcnt(18)
    v_mfma_f32_32x32x16_bf16 v[16:31], v[80:83], v[176:179], v[16:31]
    buffer_load_dwordx4 v[160:163], v6, s[60:63], s30 offen offset:0 sc1
    v_mfma_f32_32x32x16_bf16 v[32:47], v[80:83], v[180:183], v[32:47]
    buffer_load_dwordx4 v[164:167], v6, s[60:63], s31 offen offset:0 sc1
    v_mfma_f32_32x32x16_bf16 v[48:63], v[84:87], v[176:179], v[48:63]
    buffer_load_dwordx4 v[168:171], v6, s[60:63], s30 offen offset:1024 sc1
    v_mfma_f32_32x32x16_bf16 v[64:79], v[84:87], v[180:183], v[64:79]
    buffer_load_dwordx4 v[172:175], v6, s[60:63], s31 offen offset:1024 sc1
    s_add_u32 s39, s39, 8192
    s_cmp_eq_u32 s39, 114688
    s_cselect_b32 s39, 0, s39
    s_add_u32 s30, s38, s39
    s_add_u32 s31, s30, s35
    s_waitcnt vmcnt(20)
    v_mfma_f32_32x32x16_bf16 v[16:31], v[88:91], v[184:187], v[16:31]
    v_mfma_f32_32x32x16_bf16 v[32:47], v[88:91], v[188:191], v[32:47]
    v_mfma_f32_32x32x16_bf16 v[48:63], v[92:95], v[184:187], v[48:63]
    v_mfma_f32_32x32x16_bf16 v[64:79], v[92:95], v[188:191], v[64:79]
    ds_read_b64_tr_b16 v[80:81], v8 offset:16384
    ds_read_b64_tr_b16 v[82:83], v8 offset:17408
    ds_read_b64_tr_b16 v[84:85], v9 offset:16384
    ds_read_b64_tr_b16 v[86:87], v9 offset:17408
    ds_read_b64_tr_b16 v[88:89], v8 offset:18432
    ds_read_b64_tr_b16 v[90:91], v8 offset:19456
    ds_read_b64_tr_b16 v[92:93], v9 offset:18432
    ds_read_b64_tr_b16 v[94:95], v9 offset:19456
    s_waitcnt vmcnt(18)
    v_mfma_f32_32x32x16_bf16 v[16:31], v[96:99], v[192:195], v[16:31]
    buffer_load_dwordx4 v[176:179], v6, s[60:63], s30 offen offset:0 sc1
    v_mfma_f32_32x32x16_bf16 v[32:47], v[96:99], v[196:199], v[32:47]
    buffer_load_dwordx4 v[180:183], v6, s[60:63], s31 offen offset:0 sc1
    v_mfma_f32_32x32x16_bf16 v[48:63], v[100:103], v[192:195], v[48:63]
    buffer_load_dwordx4 v[184:187], v6, s[60:63], s30 offen offset:1024 sc1
    v_mfma_f32_32x32x16_bf16 v[64:79], v[100:103], v[196:199], v[64:79]
    buffer_load_dwordx4 v[188:191], v6, s[60:63], s31 offen offset:1024 sc1
    s_add_u32 s39, s39, 8192
    s_cmp_eq_u32 s39, 114688
    s_cselect_b32 s39, 0, s39
    s_add_u32 s30, s38, s39
    s_add_u32 s31, s30, s35
    s_waitcnt vmcnt(20)
    v_mfma_f32_32x32x16_bf16 v[16:31], v[104:107], v[200:203], v[16:31]
    v_mfma_f32_32x32x16_bf16 v[32:47], v[104:107], v[204:207], v[32:47]
    v_mfma_f32_32x32x16_bf16 v[48:63], v[108:111], v[200:203], v[48:63]
    v_mfma_f32_32x32x16_bf16 v[64:79], v[108:111], v[204:207], v[64:79]
    ds_read_b64_tr_b16 v[96:97], v8 offset:32768
    ds_read_b64_tr_b16 v[98:99], v8 offset:33792
    ds_read_b64_tr_b16 v[100:101], v9 offset:32768
    ds_read_b64_tr_b16 v[102:103], v9 offset:33792
    ds_read_b64_tr_b16 v[104:105], v8 offset:34816
    ds_read_b64_tr_b16 v[106:107], v8 offset:35840
    ds_read_b64_tr_b16 v[108:109], v9 offset:34816
    ds_read_b64_tr_b16 v[110:111], v9 offset:35840
    s_waitcnt vmcnt(18)
    s_waitcnt lgkmcnt(15)
    v_mfma_f32_32x32x16_bf16 v[16:31], v[112:115], v[208:211], v[16:31]
    buffer_load_dwordx4 v[192:195], v6, s[60:63], s30 offen offset:0 sc1
    v_mfma_f32_32x32x16_bf16 v[32:47], v[112:115], v[212:215], v[32:47]
    buffer_load_dwordx4 v[196:199], v6, s[60:63], s31 offen offset:0 sc1
    v_mfma_f32_32x32x16_bf16 v[48:63], v[116:119], v[208:211], v[48:63]
    buffer_load_dwordx4 v[200:203], v6, s[60:63], s30 offen offset:1024 sc1
    v_mfma_f32_32x32x16_bf16 v[64:79], v[116:119], v[212:215], v[64:79]
    buffer_load_dwordx4 v[204:207], v6, s[60:63], s31 offen offset:1024 sc1
    s_add_u32 s39, s39, 8192
    s_cmp_eq_u32 s39, 114688
    s_cselect_b32 s39, 0, s39
    s_add_u32 s30, s38, s39
    s_add_u32 s31, s30, s35
    s_waitcnt vmcnt(20)
    v_mfma_f32_32x32x16_bf16 v[16:31], v[120:123], v[216:219], v[16:31]
    v_mfma_f32_32x32x16_bf16 v[32:47], v[120:123], v[220:223], v[32:47]
    v_mfma_f32_32x32x16_bf16 v[48:63], v[124:127], v[216:219], v[48:63]
    v_mfma_f32_32x32x16_bf16 v[64:79], v[124:127], v[220:223], v[64:79]
    ds_read_b64_tr_b16 v[112:113], v8 offset:49152
    ds_read_b64_tr_b16 v[114:115], v8 offset:50176
    ds_read_b64_tr_b16 v[116:117], v9 offset:49152
    ds_read_b64_tr_b16 v[118:119], v9 offset:50176
    ds_read_b64_tr_b16 v[120:121], v8 offset:51200
    ds_read_b64_tr_b16 v[122:123], v8 offset:52224
    ds_read_b64_tr_b16 v[124:125], v9 offset:51200
    ds_read_b64_tr_b16 v[126:127], v9 offset:52224
    s_waitcnt vmcnt(18)
    v_mfma_f32_32x32x16_bf16 v[16:31], v[128:131], v[224:227], v[16:31]
    buffer_load_dwordx4 v[208:211], v6, s[60:63], s30 offen offset:0 sc1
    v_mfma_f32_32x32x16_bf16 v[32:47], v[128:131], v[228:231], v[32:47]
    buffer_load_dwordx4 v[212:215], v6, s[60:63], s31 offen offset:0 sc1
    v_mfma_f32_32x32x16_bf16 v[48:63], v[132:135], v[224:227], v[48:63]
    buffer_load_dwordx4 v[216:219], v6, s[60:63], s30 offen offset:1024 sc1
    v_mfma_f32_32x32x16_bf16 v[64:79], v[132:135], v[228:231], v[64:79]
    buffer_load_dwordx4 v[220:223], v6, s[60:63], s31 offen offset:1024 sc1
    s_add_u32 s39, s39, 8192
    s_cmp_eq_u32 s39, 114688
    s_cselect_b32 s39, 0, s39
    s_add_u32 s30, s38, s39
    s_add_u32 s31, s30, s35
    s_waitcnt vmcnt(20)
    v_mfma_f32_32x32x16_bf16 v[16:31], v[136:139], v[232:235], v[16:31]
    v_mfma_f32_32x32x16_bf16 v[32:47], v[136:139], v[236:239], v[32:47]
    v_mfma_f32_32x32x16_bf16 v[48:63], v[140:143], v[232:235], v[48:63]
    v_mfma_f32_32x32x16_bf16 v[64:79], v[140:143], v[236:239], v[64:79]
    ds_read_b64_tr_b16 v[128:129], v10 offset:0
    ds_read_b64_tr_b16 v[130:131], v10 offset:1024
    ds_read_b64_tr_b16 v[132:133], v11 offset:0
    ds_read_b64_tr_b16 v[134:135], v11 offset:1024
    ds_read_b64_tr_b16 v[136:137], v10 offset:2048
    ds_read_b64_tr_b16 v[138:139], v10 offset:3072
    ds_read_b64_tr_b16 v[140:141], v11 offset:2048
    ds_read_b64_tr_b16 v[142:143], v11 offset:3072
    s_waitcnt vmcnt(18)
    v_mfma_f32_32x32x16_bf16 v[16:31], v[144:147], v[240:243], v[16:31]
    v_mfma_f32_32x32x16_bf16 v[32:47], v[144:147], v[244:247], v[32:47]
    v_mfma_f32_32x32x16_bf16 v[48:63], v[148:151], v[240:243], v[48:63]
    v_mfma_f32_32x32x16_bf16 v[64:79], v[148:151], v[244:247], v[64:79]
    s_waitcnt vmcnt(16)
    v_mfma_f32_32x32x16_bf16 v[16:31], v[152:155], v[248:251], v[16:31]
    v_mfma_f32_32x32x16_bf16 v[32:47], v[152:155], v[252:255], v[32:47]
    v_mfma_f32_32x32x16_bf16 v[48:63], v[156:159], v[248:251], v[48:63]
    v_mfma_f32_32x32x16_bf16 v[64:79], v[156:159], v[252:255], v[64:79]
    s_waitcnt lgkmcnt(0)
    s_barrier
    s_waitcnt vmcnt(14)
    v_mfma_f32_32x32x16_bf16 v[16:31], v[80:83], v[160:163], v[16:31]
    v_mfma_f32_32x32x16_bf16 v[32:47], v[80:83], v[164:167], v[32:47]
    v_mfma_f32_32x32x16_bf16 v[48:63], v[84:87], v[160:163], v[48:63]
    v_mfma_f32_32x32x16_bf16 v[64:79], v[84:87], v[164:167], v[64:79]
    s_waitcnt vmcnt(12)
    v_mfma_f32_32x32x16_bf16 v[16:31], v[88:91], v[168:171], v[16:31]
    v_mfma_f32_32x32x16_bf16 v[32:47], v[88:91], v[172:175], v[32:47]
    v_mfma_f32_32x32x16_bf16 v[48:63], v[92:95], v[168:171], v[48:63]
    v_mfma_f32_32x32x16_bf16 v[64:79], v[92:95], v[172:175], v[64:79]
    s_mov_b32 s8, s54
    s_mov_b32 s9, s55
    s_mov_b32 s10, 0x1c0000
    s_mov_b32 s11, 0x00020000
    v_and_b32 v1, 31, v2
    s_lshl_b32 s28, s26, 7
    v_lshl_add_u32 v7, v1, 2, s28
    v_add_u32 v7, 157696, v7
    ds_read_b32 v88, v7
    ds_read_b64_tr_b16 v[80:81], v14 offset:0
    ds_read_b64_tr_b16 v[82:83], v14 offset:1024
    ds_read_b64_tr_b16 v[84:85], v14 offset:2048
    ds_read_b64_tr_b16 v[86:87], v14 offset:3072
    v_mul_u32_u24 v1, 896, v1
    v_lshl_add_u32 v1, v4, 4, v1
    s_mul_i32 s28, s23, 12288
    v_add_u32 v5, s28, v6
    s_xor_b32 s28, s23, 1
    s_mul_i32 s28, s28, 12288
    v_add_u32 v9, s28, v6
    s_xor_b32 s28, s23, 2
    s_mul_i32 s28, s28, 12288
    v_add_u32 v10, s28, v6
    s_xor_b32 s28, s23, 3
    s_mul_i32 s28, s28, 12288
    v_add_u32 v11, s28, v6
    s_waitcnt vmcnt(10)
    v_mfma_f32_32x32x16_bf16 v[16:31], v[96:99], v[176:179], v[16:31]
    v_mfma_f32_32x32x16_bf16 v[32:47], v[96:99], v[180:183], v[32:47]
    v_mfma_f32_32x32x16_bf16 v[48:63], v[100:103], v[176:179], v[48:63]
    v_mfma_f32_32x32x16_bf16 v[64:79], v[100:103], v[180:183], v[64:79]
    s_waitcnt vmcnt(8)
    v_mfma_f32_32x32x16_bf16 v[16:31], v[104:107], v[184:187], v[16:31]
    v_mfma_f32_32x32x16_bf16 v[32:47], v[104:107], v[188:191], v[32:47]
    v_mfma_f32_32x32x16_bf16 v[48:63], v[108:111], v[184:187], v[48:63]
    v_mfma_f32_32x32x16_bf16 v[64:79], v[108:111], v[188:191], v[64:79]
    s_waitcnt vmcnt(6)
    v_mfma_f32_32x32x16_bf16 v[16:31], v[112:115], v[192:195], v[16:31]
    v_mfma_f32_32x32x16_bf16 v[32:47], v[112:115], v[196:199], v[32:47]
    v_mfma_f32_32x32x16_bf16 v[48:63], v[116:119], v[192:195], v[48:63]
    v_mfma_f32_32x32x16_bf16 v[64:79], v[116:119], v[196:199], v[64:79]
    s_waitcnt vmcnt(4)
    v_mfma_f32_32x32x16_bf16 v[16:31], v[120:123], v[200:203], v[16:31]
    v_mfma_f32_32x32x16_bf16 v[32:47], v[120:123], v[204:207], v[32:47]
    v_mfma_f32_32x32x16_bf16 v[48:63], v[124:127], v[200:203], v[48:63]
    v_mfma_f32_32x32x16_bf16 v[64:79], v[124:127], v[204:207], v[64:79]
    s_waitcnt vmcnt(0)
    v_mfma_f32_32x32x16_bf16 v[64:79], v[132:135], v[212:215], v[64:79]
    v_mfma_f32_32x32x16_bf16 v[48:63], v[132:135], v[208:211], v[48:63]
    v_mfma_f32_32x32x16_bf16 v[64:79], v[140:143], v[220:223], v[64:79]
    v_mfma_f32_32x32x16_bf16 v[48:63], v[140:143], v[216:219], v[48:63]
    v_mfma_f32_32x32x16_bf16 v[32:47], v[128:131], v[212:215], v[32:47]
    v_mfma_f32_32x32x16_bf16 v[32:47], v[136:139], v[220:223], v[32:47]
    v_mfma_f32_32x32x16_bf16 v[16:31], v[128:131], v[208:211], v[16:31]
    s_nop 7
    ds_write_b128 v11, v[64:67] offset:8192
    v_mfma_f32_32x32x16_bf16 v[16:31], v[136:139], v[216:219], v[16:31]
    ds_write_b128 v11, v[68:71] offset:9216
    ds_write_b128 v11, v[72:75] offset:10240
    ds_write_b128 v11, v[76:79] offset:11264
    ds_write_b128 v10, v[48:51] offset:4096
    ds_write_b128 v10, v[52:55] offset:5120
    ds_write_b128 v10, v[56:59] offset:6144
    ds_write_b128 v10, v[60:63] offset:7168
    ds_write_b128 v9, v[32:35] offset:0
    ds_write_b128 v9, v[36:39] offset:1024
    ds_write_b128 v9, v[40:43] offset:2048
    ds_write_b128 v9, v[44:47] offset:3072
    s_waitcnt lgkmcnt(0)
    s_barrier
    ds_read_b128 v[160:163], v5 offset:0
    ds_read_b128 v[176:179], v5 offset:4096
    ds_read_b128 v[192:195], v5 offset:8192
    ds_read_b128 v[164:167], v5 offset:1024
    ds_read_b128 v[180:183], v5 offset:5120
    ds_read_b128 v[196:199], v5 offset:9216
    ds_read_b128 v[168:171], v5 offset:2048
    ds_read_b128 v[184:187], v5 offset:6144
    ds_read_b128 v[200:203], v5 offset:10240
    ds_read_b128 v[172:175], v5 offset:3072
    ds_read_b128 v[188:191], v5 offset:7168
    ds_read_b128 v[204:207], v5 offset:11264
    v_lshlrev_b32 v104, 16, v80
    v_and_b32 v105, 0xffff0000, v80
    v_lshlrev_b32 v106, 16, v81
    v_and_b32 v107, 0xffff0000, v81
    v_lshlrev_b32 v108, 16, v82
    v_and_b32 v109, 0xffff0000, v82
    v_lshlrev_b32 v110, 16, v83
    v_and_b32 v111, 0xffff0000, v83
    v_lshlrev_b32 v112, 16, v84
    v_and_b32 v113, 0xffff0000, v84
    v_lshlrev_b32 v114, 16, v85
    v_and_b32 v115, 0xffff0000, v85
    v_lshlrev_b32 v116, 16, v86
    v_and_b32 v117, 0xffff0000, v86
    v_lshlrev_b32 v118, 16, v87
    v_and_b32 v119, 0xffff0000, v87
    s_waitcnt lgkmcnt(10)
    v_pk_add_f32 v[160:161], v[160:161], v[176:177]
    s_waitcnt lgkmcnt(9)
    v_pk_add_f32 v[16:17], v[16:17], v[192:193]
    v_pk_add_f32 v[16:17], v[16:17], v[160:161]
    v_pk_fma_f32 v[16:17], v[16:17], v[88:89], v[104:105] op_sel_hi:[1,0,1]
    v_cvt_pk_bf16_f32 v96, v16, v17
    v_pk_add_f32 v[162:163], v[162:163], v[178:179]
    v_pk_add_f32 v[18:19], v[18:19], v[194:195]
    v_pk_add_f32 v[18:19], v[18:19], v[162:163]
    v_pk_fma_f32 v[18:19], v[18:19], v[88:89], v[106:107] op_sel_hi:[1,0,1]
    v_cvt_pk_bf16_f32 v97, v18, v19
    s_waitcnt lgkmcnt(7)
    v_pk_add_f32 v[164:165], v[164:165], v[180:181]
    s_waitcnt lgkmcnt(6)
    v_pk_add_f32 v[20:21], v[20:21], v[196:197]
    v_pk_add_f32 v[20:21], v[20:21], v[164:165]
    v_pk_fma_f32 v[20:21], v[20:21], v[88:89], v[108:109] op_sel_hi:[1,0,1]
    v_cvt_pk_bf16_f32 v98, v20, v21
    v_pk_add_f32 v[166:167], v[166:167], v[182:183]
    v_pk_add_f32 v[22:23], v[22:23], v[198:199]
    v_pk_add_f32 v[22:23], v[22:23], v[166:167]
    v_pk_fma_f32 v[22:23], v[22:23], v[88:89], v[110:111] op_sel_hi:[1,0,1]
    v_cvt_pk_bf16_f32 v99, v22, v23
    s_nop 1
    v_permlane32_swap_b32 v96, v98
    v_permlane32_swap_b32 v97, v99
    buffer_store_dwordx4 v[96:99], v1, s[8:11], s29 offen offset:0
    s_waitcnt lgkmcnt(4)
    v_pk_add_f32 v[168:169], v[168:169], v[184:185]
    s_waitcnt lgkmcnt(3)
    v_pk_add_f32 v[24:25], v[24:25], v[200:201]
    v_pk_add_f32 v[24:25], v[24:25], v[168:169]
    v_pk_fma_f32 v[24:25], v[24:25], v[88:89], v[112:113] op_sel_hi:[1,0,1]
    v_cvt_pk_bf16_f32 v100, v24, v25
    v_pk_add_f32 v[170:171], v[170:171], v[186:187]
    v_pk_add_f32 v[26:27], v[26:27], v[202:203]
    v_pk_add_f32 v[26:27], v[26:27], v[170:171]
    v_pk_fma_f32 v[26:27], v[26:27], v[88:89], v[114:115] op_sel_hi:[1,0,1]
    v_cvt_pk_bf16_f32 v101, v26, v27
    s_waitcnt lgkmcnt(1)
    v_pk_add_f32 v[172:173], v[172:173], v[188:189]
    s_waitcnt lgkmcnt(0)
    v_pk_add_f32 v[28:29], v[28:29], v[204:205]
    v_pk_add_f32 v[28:29], v[28:29], v[172:173]
    v_pk_fma_f32 v[28:29], v[28:29], v[88:89], v[116:117] op_sel_hi:[1,0,1]
    v_cvt_pk_bf16_f32 v102, v28, v29
    v_pk_add_f32 v[174:175], v[174:175], v[190:191]
    v_pk_add_f32 v[30:31], v[30:31], v[206:207]
    v_pk_add_f32 v[30:31], v[30:31], v[174:175]
    v_pk_fma_f32 v[30:31], v[30:31], v[88:89], v[118:119] op_sel_hi:[1,0,1]
    v_cvt_pk_bf16_f32 v103, v30, v31
    s_nop 1
    v_permlane32_swap_b32 v100, v102
    v_permlane32_swap_b32 v101, v103
    buffer_store_dwordx4 v[100:103], v1, s[8:11], s29 offen offset:32
    s_endpgm
LOADER:
    s_waitcnt vmcnt(2)
    ds_write_b128 v7, v[112:115] offset:9152
    v_lshlrev_b32 v148, 16, v112
    v_and_b32 v149, 0xffff0000, v112
    v_lshlrev_b32 v150, 16, v113
    v_and_b32 v151, 0xffff0000, v113
    v_lshlrev_b32 v152, 16, v114
    v_and_b32 v153, 0xffff0000, v114
    v_lshlrev_b32 v154, 16, v115
    v_and_b32 v155, 0xffff0000, v115
    s_waitcnt vmcnt(0)
    v_subrev_f32_dpp v148, v132, v148 quad_perm:[0,0,2,2] row_mask:0xf bank_mask:0xf
    v_subrev_f32_dpp v149, v133, v149 quad_perm:[0,0,2,2] row_mask:0xf bank_mask:0xf
    v_subrev_f32_dpp v150, v134, v150 quad_perm:[0,0,2,2] row_mask:0xf bank_mask:0xf
    v_subrev_f32_dpp v151, v135, v151 quad_perm:[0,0,2,2] row_mask:0xf bank_mask:0xf
    v_subrev_f32_dpp v152, v136, v152 quad_perm:[0,0,2,2] row_mask:0xf bank_mask:0xf
    v_subrev_f32_dpp v153, v137, v153 quad_perm:[0,0,2,2] row_mask:0xf bank_mask:0xf
    v_subrev_f32_dpp v154, v138, v154 quad_perm:[0,0,2,2] row_mask:0xf bank_mask:0xf
    v_subrev_f32_dpp v155, v139, v155 quad_perm:[0,0,2,2] row_mask:0xf bank_mask:0xf
    v_cvt_pk_bf16_f32 v116, v148, v149
    v_cvt_pk_bf16_f32 v117, v150, v151
    v_cvt_pk_bf16_f32 v118, v152, v153
    v_cvt_pk_bf16_f32 v119, v154, v155
    v_lshlrev_b32 v148, 16, v116
    v_and_b32 v149, 0xffff0000, v116
    v_lshlrev_b32 v150, 16, v117
    v_and_b32 v151, 0xffff0000, v117
    v_lshlrev_b32 v152, 16, v118
    v_and_b32 v153, 0xffff0000, v118
    v_lshlrev_b32 v154, 16, v119
    v_and_b32 v155, 0xffff0000, v119
    v_mul_f32_dpp v148, v132, v148 quad_perm:[1,1,3,3] row_mask:0xf bank_mask:0xf
    v_mul_f32_dpp v149, v133, v149 quad_perm:[1,1,3,3] row_mask:0xf bank_mask:0xf
    v_mul_f32_dpp v150, v134, v150 quad_perm:[1,1,3,3] row_mask:0xf bank_mask:0xf
    v_mul_f32_dpp v151, v135, v151 quad_perm:[1,1,3,3] row_mask:0xf bank_mask:0xf
    v_mul_f32_dpp v152, v136, v152 quad_perm:[1,1,3,3] row_mask:0xf bank_mask:0xf
    v_mul_f32_dpp v153, v137, v153 quad_perm:[1,1,3,3] row_mask:0xf bank_mask:0xf
    v_mul_f32_dpp v154, v138, v154 quad_perm:[1,1,3,3] row_mask:0xf bank_mask:0xf
    v_mul_f32_dpp v155, v139, v155 quad_perm:[1,1,3,3] row_mask:0xf bank_mask:0xf
    v_cvt_pk_bf16_f32 v116, v148, v149
    v_cvt_pk_bf16_f32 v117, v150, v151
    v_cvt_pk_bf16_f32 v118, v152, v153
    v_cvt_pk_bf16_f32 v119, v154, v155
    v_cvt_pk_bf16_f32 v44, v149, v150
    v_cvt_pk_bf16_f32 v46, v151, v152
    v_cvt_pk_bf16_f32 v47, v153, v154
    ds_write_b128 v7, v[116:119] offset:448
    ds_write_b16 v7, v116 offset:5026
    ds_write_b32 v7, v44 offset:5028
    ds_write_b64 v7, v[46:47] offset:5032
    ds_write_b16_d16_hi v7, v119 offset:5040
    v_min_u32 v16, 55, v2
    s_mul_i32 s36, s3, 7168
    v_lshl_add_u32 v16, v16, 7, s36
    s_cmp_eq_u32 s22, 4
    s_cselect_b32 s34, s48, s50
    s_cselect_b32 s35, s49, s51
    s_cmp_ge_u32 s22, 6
    s_cselect_b32 s34, s52, s34
    s_cselect_b32 s35, s53, s35
    global_load_dword v31, v16, s[34:35]
    s_waitcnt lgkmcnt(0)
    s_barrier
    v_lshrrev_b32 v4, 5, v2
    v_lshrrev_b32 v9, 4, v2
    v_lshlrev_b32 v10, 2, v9
    v_and_b32 v11, 15, v2
    v_xor_b32 v10, v10, v11
    s_lshl_b32 s26, s23, 3
    v_add_u32 v9, s26, v9
    v_lshlrev_b32 v11, 8, v9
    v_lshl_add_u32 v11, v10, 4, v11
    v_mul_u32_u24 v12, 3584, v9
    v_lshl_add_u32 v12, v10, 4, v12
    s_lshl_b32 s26, s25, 8
    v_add_u32 v12, s26, v12
    v_add_u32 v13, 13312, v12
    s_lshl_b32 s27, s23, 11
    s_mov_b32 s29, 0
    s_mul_i32 s30, s24, 114944
    s_add_u32 s30, s30, 0x100000
    v_and_b32 v14, 31, v2
    v_lshlrev_b32 v14, 4, v14
    v_mul_u32_u24 v15, 7168, v4
    v_add_u32 v14, v14, v15
    v_lshrrev_b32 v3, 3, v2
    v_and_b32 v5, 7, v2
    s_lshl_b32 s28, s23, 5
    v_add_u32 v6, s28, v3
    v_mul_u32_u24 v16, 896, v6
    v_lshl_add_u32 v16, v5, 4, v16
    s_lshl_b32 s28, s47, 7
    v_add_u32 v16, s28, v16
    v_bfe_u32 v7, v2, 4, 1
    v_lshlrev_b32 v7, 2, v7
    v_xor_b32 v7, v7, v5
    v_lshlrev_b32 v24, 7, v6
    v_lshl_add_u32 v24, v7, 4, v24
    v_add_u32 v25, 0x10000, v24
    v_add_u32 v26, 0x20000, v24
    s_lshl_b32 s28, s23, 4
    v_add_u32 v6, s28, v3
    v_lshlrev_b32 v18, 8, v6
    v_lshl_add_u32 v18, v7, 4, v18
    v_add_u32 v19, 1024, v18
    v_lshlrev_b32 v20, 2, v2
    s_lshr_b32 s38, s24, 1
    s_lshl_b32 s38, s38, 7
    s_and_b32 s28, s24, 1
    s_lshl_b32 s28, s28, 3
    s_add_u32 s38, s38, s28
    s_add_u32 s38, s38, s40
    s_add_u32 s38, s38, 0x60000
    s_mul_i32 s35, s25, 0x1c000
    s_mov_b32 s4, s48
    s_mov_b32 s5, s49
    s_mov_b32 s6, 0x188000
    s_mov_b32 s7, 0x00020000
    s_mov_b32 s8, s50
    s_mov_b32 s9, s51
    s_mov_b32 s10, 0x188000
    s_mov_b32 s11, 0x00020000
    s_mov_b32 s12, s52
    s_mov_b32 s13, s53
    s_mov_b32 s14, 0x188000
    s_mov_b32 s15, 0x00020000
    s_add_u32 m0, s27, 8192
    s_nop 0
    buffer_load_dwordx4 v12, s[4:7], s29 offen lds
    buffer_load_dwordx4 v13, s[4:7], s29 offen offset:1024 lds
    s_add_u32 m0, s27, 16384
    s_nop 0
    buffer_load_dwordx4 v12, s[8:11], s29 offen lds
    buffer_load_dwordx4 v13, s[8:11], s29 offen offset:1024 lds
    s_add_u32 s29, s29, 0x1c000
    s_add_u32 m0, s27, 32768
    s_nop 0
    buffer_load_dwordx4 v12, s[4:7], s29 offen lds
    buffer_load_dwordx4 v13, s[4:7], s29 offen offset:1024 lds
    s_add_u32 m0, s27, 40960
    s_nop 0
    buffer_load_dwordx4 v12, s[8:11], s29 offen lds
    buffer_load_dwordx4 v13, s[8:11], s29 offen offset:1024 lds
    s_add_u32 s29, s29, 0x1c000
    buffer_load_dwordx4 v[32:35], v16, s[12:15], s35 offen
    s_add_u32 s35, s35, 7168
    buffer_load_dwordx4 v[36:39], v16, s[12:15], s35 offen
    s_add_u32 s35, s35, 7168
    buffer_load_dwordx4 v[40:43], v16, s[12:15], s35 offen
    s_add_u32 s35, s35, 7168
    buffer_load_dwordx4 v[44:47], v16, s[12:15], s35 offen
    s_add_u32 s35, s35, 0x16c00
    s_cmp_eq_u32 s35, 0x188000
    s_cselect_b32 s35, 0, s35
    buffer_load_dwordx4 v[48:51], v16, s[12:15], s35 offen
    s_add_u32 s35, s35, 7168
    buffer_load_dwordx4 v[52:55], v16, s[12:15], s35 offen
    s_add_u32 s35, s35, 7168
    buffer_load_dwordx4 v[56:59], v16, s[12:15], s35 offen
    s_add_u32 s35, s35, 7168
    buffer_load_dwordx4 v[60:63], v16, s[12:15], s35 offen
    s_add_u32 s35, s35, 0x16c00
    s_cmp_eq_u32 s35, 0x188000
    s_cselect_b32 s35, 0, s35
    buffer_load_dwordx4 v[64:67], v16, s[12:15], s35 offen
    s_add_u32 s35, s35, 7168
    buffer_load_dwordx4 v[68:71], v16, s[12:15], s35 offen
    s_add_u32 s35, s35, 7168
    buffer_load_dwordx4 v[72:75], v16, s[12:15], s35 offen
    s_add_u32 s35, s35, 7168
    buffer_load_dwordx4 v[76:79], v16, s[12:15], s35 offen
    s_add_u32 s35, s35, 0x16c00
    s_cmp_eq_u32 s35, 0x188000
    s_cselect_b32 s35, 0, s35
    buffer_load_dwordx4 v[80:83], v16, s[12:15], s35 offen
    s_add_u32 s35, s35, 7168
    buffer_load_dwordx4 v[84:87], v16, s[12:15], s35 offen
    s_add_u32 s35, s35, 7168
    buffer_load_dwordx4 v[88:91], v16, s[12:15], s35 offen
    s_add_u32 s35, s35, 7168
    buffer_load_dwordx4 v[92:95], v16, s[12:15], s35 offen
    s_add_u32 s35, s35, 0x16c00
    s_cmp_eq_u32 s35, 0x188000
    s_cselect_b32 s35, 0, s35
    buffer_load_dwordx4 v[96:99], v16, s[12:15], s35 offen
    s_add_u32 s35, s35, 7168
    buffer_load_dwordx4 v[100:103], v16, s[12:15], s35 offen
    s_add_u32 s35, s35, 7168
    buffer_load_dwordx4 v[104:107], v16, s[12:15], s35 offen
    s_add_u32 s35, s35, 7168
    buffer_load_dwordx4 v[108:111], v16, s[12:15], s35 offen
    s_add_u32 s35, s35, 0x16c00
    s_cmp_eq_u32 s35, 0x188000
    s_cselect_b32 s35, 0, s35
    s_barrier
    s_waitcnt vmcnt(12)
    s_add_u32 m0, s27, 57344
    s_nop 0
    buffer_load_dwordx4 v12, s[4:7], s29 offen lds
    buffer_load_dwordx4 v13, s[4:7], s29 offen offset:1024 lds
    s_add_u32 m0, s27, 65536
    s_nop 0
    buffer_load_dwordx4 v12, s[8:11], s29 offen lds
    buffer_load_dwordx4 v13, s[8:11], s29 offen offset:1024 lds
    s_add_u32 s29, s29, 0x1c000
    s_add_u32 m0, s27, 81920
    s_nop 0
    buffer_load_dwordx4 v12, s[4:7], s29 offen lds
    buffer_load_dwordx4 v13, s[4:7], s29 offen offset:1024 lds
    s_add_u32 m0, s27, 90112
    s_nop 0
    buffer_load_dwordx4 v12, s[8:11], s29 offen lds
    buffer_load_dwordx4 v13, s[8:11], s29 offen offset:1024 lds
    s_add_u32 s29, s29, 0x1c000
    s_add_u32 m0, s27, 106496
    s_nop 0
    buffer_load_dwordx4 v12, s[4:7], s29 offen lds
    buffer_load_dwordx4 v13, s[4:7], s29 offen offset:1024 lds
    s_add_u32 m0, s27, 114688
    s_nop 0
    buffer_load_dwordx4 v12, s[8:11], s29 offen lds
    buffer_load_dwordx4 v13, s[8:11], s29 offen offset:1024 lds
    s_add_u32 s29, s29, 0x1c000
    s_add_u32 m0, s27, 131072
    s_nop 0
    buffer_load_dwordx4 v12, s[4:7], s29 offen lds
    buffer_load_dwordx4 v13, s[4:7], s29 offen offset:1024 lds
    s_add_u32 m0, s27, 139264
    s_nop 0
    buffer_load_dwordx4 v12, s[8:11], s29 offen lds
    buffer_load_dwordx4 v13, s[8:11], s29 offen offset:1024 lds
    s_add_u32 s29, s29, 0x1c000
    s_barrier
    s_setprio 1
    s_add_u32 m0, s27, 0
    s_nop 0
    buffer_load_dwordx4 v11, s[60:63], s30 offen sc1 lds
    buffer_load_dwordx4 v11, s[60:63], s30 offen offset:1024 sc1 lds
    s_add_u32 s30, s30, 8192
    s_add_u32 m0, s27, 24576
    s_nop 0
    buffer_load_dwordx4 v11, s[60:63], s30 offen sc1 lds
    buffer_load_dwordx4 v11, s[60:63], s30 offen offset:1024 sc1 lds
    s_add_u32 s30, s30, 8192
    s_add_u32 m0, s27, 49152
    s_nop 0
    buffer_load_dwordx4 v11, s[60:63], s30 offen sc1 lds
    buffer_load_dwordx4 v11, s[60:63], s30 offen offset:1024 sc1 lds
    s_add_u32 s30, s30, 8192
    s_add_u32 m0, s27, 73728
    s_nop 0
    buffer_load_dwordx4 v11, s[60:63], s30 offen sc1 lds
    buffer_load_dwordx4 v11, s[60:63], s30 offen offset:1024 sc1 lds
    s_add_u32 s30, s30, 8192
    s_add_u32 m0, s27, 98304
    s_nop 0
    buffer_load_dwordx4 v11, s[60:63], s30 offen sc1 lds
    buffer_load_dwordx4 v11, s[60:63], s30 offen offset:1024 sc1 lds
    s_add_u32 s30, s30, 8192
    s_add_u32 m0, s27, 122880
    s_nop 0
    buffer_load_dwordx4 v11, s[60:63], s30 offen sc1 lds
    buffer_load_dwordx4 v11, s[60:63], s30 offen offset:1024 sc1 lds
    s_add_u32 s30, s30, 8192
    s_waitcnt vmcnt(10)
    s_barrier
    s_waitcnt vmcnt(6)
    s_barrier
    s_add_u32 m0, s27, 0
    s_nop 0
    buffer_load_dwordx4 v11, s[60:63], s30 offen sc1 lds
    buffer_load_dwordx4 v11, s[60:63], s30 offen offset:1024 sc1 lds
    s_add_u32 s30, s30, 8192
    s_add_u32 m0, s27, 8192
    s_nop 0
    buffer_load_dwordx4 v12, s[4:7], s29 offen lds
    buffer_load_dwordx4 v13, s[4:7], s29 offen offset:1024 lds
    s_add_u32 m0, s27, 16384
    s_nop 0
    buffer_load_dwordx4 v12, s[8:11], s29 offen lds
    buffer_load_dwordx4 v13, s[8:11], s29 offen offset:1024 lds
    s_add_u32 s29, s29, 0x1c000
    buffer_load_dwordx4 v[112:115], v16, s[12:15], s35 offen
    s_add_u32 s35, s35, 7168
    buffer_load_dwordx4 v[116:119], v16, s[12:15], s35 offen
    s_add_u32 s35, s35, 7168
    buffer_load_dwordx4 v[120:123], v16, s[12:15], s35 offen
    s_add_u32 s35, s35, 7168
    buffer_load_dwordx4 v[124:127], v16, s[12:15], s35 offen
    s_add_u32 s35, s35, 0x16c00
    s_cmp_eq_u32 s35, 0x188000
    s_cselect_b32 s35, 0, s35
    buffer_load_dwordx4 v[128:131], v16, s[12:15], s35 offen
    s_add_u32 s35, s35, 7168
    buffer_load_dwordx4 v[132:135], v16, s[12:15], s35 offen
    s_add_u32 s35, s35, 7168
    buffer_load_dwordx4 v[136:139], v16, s[12:15], s35 offen
    s_add_u32 s35, s35, 7168
    buffer_load_dwordx4 v[140:143], v16, s[12:15], s35 offen
    s_add_u32 s35, s35, 0x16c00
    s_cmp_eq_u32 s35, 0x188000
    s_cselect_b32 s35, 0, s35
    s_waitcnt vmcnt(16)
    s_barrier
    s_add_u32 m0, s27, 24576
    s_nop 0
    buffer_load_dwordx4 v11, s[60:63], s30 offen sc1 lds
    buffer_load_dwordx4 v11, s[60:63], s30 offen offset:1024 sc1 lds
    s_add_u32 s30, s30, 8192
    s_add_u32 m0, s27, 32768
    s_nop 0
    buffer_load_dwordx4 v12, s[4:7], s29 offen lds
    buffer_load_dwordx4 v13, s[4:7], s29 offen offset:1024 lds
    s_add_u32 m0, s27, 40960
    s_nop 0
    buffer_load_dwordx4 v12, s[8:11], s29 offen lds
    buffer_load_dwordx4 v13, s[8:11], s29 offen offset:1024 lds
    s_add_u32 s29, s29, 0x1c000
    s_add_u32 m0, s27, 49152
    s_nop 0
    buffer_load_dwordx4 v11, s[60:63], s30 offen sc1 lds
    buffer_load_dwordx4 v11, s[60:63], s30 offen offset:1024 sc1 lds
    s_add_u32 s30, s30, 8192
    s_add_u32 m0, s27, 57344
    s_nop 0
    buffer_load_dwordx4 v12, s[4:7], s29 offen lds
    buffer_load_dwordx4 v13, s[4:7], s29 offen offset:1024 lds
    s_add_u32 m0, s27, 65536
    s_nop 0
    buffer_load_dwordx4 v12, s[8:11], s29 offen lds
    buffer_load_dwordx4 v13, s[8:11], s29 offen offset:1024 lds
    s_add_u32 s29, s29, 0x1c000
    s_waitcnt vmcnt(20)
    s_barrier
    s_add_u32 m0, s27, 73728
    s_nop 0
    buffer_load_dwordx4 v11, s[60:63], s30 offen sc1 lds
    buffer_load_dwordx4 v11, s[60:63], s30 offen offset:1024 sc1 lds
    s_add_u32 s30, s30, 8192
    s_add_u32 m0, s27, 81920
    s_nop 0
    buffer_load_dwordx4 v12, s[4:7], s29 offen lds
    buffer_load_dwordx4 v13, s[4:7], s29 offen offset:1024 lds
    s_add_u32 m0, s27, 90112
    s_nop 0
    buffer_load_dwordx4 v12, s[8:11], s29 offen lds
    buffer_load_dwordx4 v13, s[8:11], s29 offen offset:1024 lds
    s_add_u32 s29, s29, 0x1c000
    s_add_u32 m0, s27, 98304
    s_nop 0
    buffer_load_dwordx4 v11, s[60:63], s30 offen sc1 lds
    buffer_load_dwordx4 v11, s[60:63], s30 offen offset:1024 sc1 lds
    s_add_u32 s30, s30, 8192
    s_add_u32 m0, s27, 106496
    s_nop 0
    buffer_load_dwordx4 v12, s[4:7], s29 offen lds
    buffer_load_dwordx4 v13, s[4:7], s29 offen offset:1024 lds
    s_add_u32 m0, s27, 114688
    s_nop 0
    buffer_load_dwordx4 v12, s[8:11], s29 offen lds
    buffer_load_dwordx4 v13, s[8:11], s29 offen offset:1024 lds
    s_add_u32 s29, s29, 0x1c000
    s_waitcnt vmcnt(12)
    s_barrier
    s_add_u32 m0, s27, 122880
    s_nop 0
    buffer_load_dwordx4 v11, s[60:63], s30 offen sc1 lds
    buffer_load_dwordx4 v11, s[60:63], s30 offen offset:1024 sc1 lds
    s_add_u32 s30, s30, 8192
    s_add_u32 m0, s27, 131072
    s_nop 0
    buffer_load_dwordx4 v12, s[4:7], s29 offen lds
    buffer_load_dwordx4 v13, s[4:7], s29 offen offset:1024 lds
    s_add_u32 m0, s27, 139264
    s_nop 0
    buffer_load_dwordx4 v12, s[8:11], s29 offen lds
    buffer_load_dwordx4 v13, s[8:11], s29 offen offset:1024 lds
    s_add_u32 s29, s29, 0x1c000
    s_add_u32 m0, s27, 0
    s_nop 0
    buffer_load_dwordx4 v11, s[60:63], s30 offen sc1 lds
    buffer_load_dwordx4 v11, s[60:63], s30 offen offset:1024 sc1 lds
    s_add_u32 s30, s30, 8192
    s_add_u32 m0, s27, 8192
    s_nop 0
    buffer_load_dwordx4 v12, s[4:7], s29 offen lds
    buffer_load_dwordx4 v13, s[4:7], s29 offen offset:1024 lds
    s_add_u32 m0, s27, 16384
    s_nop 0
    buffer_load_dwordx4 v12, s[8:11], s29 offen lds
    buffer_load_dwordx4 v13, s[8:11], s29 offen offset:1024 lds
    s_add_u32 s29, s29, 0x1c000
    s_waitcnt vmcnt(12)
    buffer_load_dwordx2 v[28:29], off, s[60:63], s38 sc1
    s_barrier
    s_add_u32 m0, s27, 24576
    s_nop 0
    buffer_load_dwordx4 v11, s[60:63], s30 offen sc1 lds
    buffer_load_dwordx4 v11, s[60:63], s30 offen offset:1024 sc1 lds
    s_add_u32 s30, s30, 8192
    s_add_u32 m0, s27, 32768
    s_nop 0
    buffer_load_dwordx4 v12, s[4:7], s29 offen lds
    buffer_load_dwordx4 v13, s[4:7], s29 offen offset:1024 lds
    s_add_u32 m0, s27, 40960
    s_nop 0
    buffer_load_dwordx4 v12, s[8:11], s29 offen lds
    buffer_load_dwordx4 v13, s[8:11], s29 offen offset:1024 lds
    s_add_u32 s29, s29, 0x1c000
    buffer_load_dwordx4 v[144:147], v16, s[12:15], s35 offen
    s_add_u32 s35, s35, 7168
    buffer_load_dwordx4 v[148:151], v16, s[12:15], s35 offen
    s_add_u32 s35, s35, 7168
    buffer_load_dwordx4 v[152:155], v16, s[12:15], s35 offen
    s_add_u32 s35, s35, 7168
    buffer_load_dwordx4 v[156:159], v16, s[12:15], s35 offen
    s_add_u32 s35, s35, 0x16c00
    s_cmp_eq_u32 s35, 0x188000
    s_cselect_b32 s35, 0, s35
    buffer_load_dwordx4 v[160:163], v16, s[12:15], s35 offen
    s_add_u32 s35, s35, 7168
    buffer_load_dwordx4 v[164:167], v16, s[12:15], s35 offen
    s_add_u32 s35, s35, 7168
    s_waitcnt vmcnt(12)
    v_xor_b32 v28, s42, v28
    v_xor_b32 v29, s42, v29
    v_or_b32 v28, v28, v29
    v_cmp_eq_u32 vcc, 0, v28
    s_nop 3
    s_cmp_eq_u64 vcc, exec
    s_cselect_b32 s39, 1, 0
    s_cbranch_scc0 L_x1
    s_lshl_b32 s26, s25, 9
    s_add_u32 s26, s26, 0x10000
    s_mov_b32 m0, 147456
    s_lshl_b32 s28, s24, 9
    buffer_load_dwordx4 v14, s[60:63], s26 offen sc1 lds
    s_and_b32 s26, s23, 1
    s_lshl_b32 s26, s26, 8
    s_add_u32 s28, s28, s26
    s_add_u32 s28, s28, 0x30000
    s_add_u32 m0, s26, 148480
    s_lshl_b32 s31, s24, 1
    buffer_load_dword v20, s[60:63], s28 offen sc1 lds
    s_add_u32 s31, s31, s46
    s_lshl_b32 s31, s31, 8
    s_add_u32 s31, s31, 0x20000
    s_mov_b32 m0, 157696
    s_mul_i32 s34, s24, 114944
    buffer_load_dword v20, s[60:63], s31 offen sc1 lds
    s_lshl_b32 s28, s46, 7
    s_add_u32 s34, s34, s28
    s_lshl_b32 s28, s47, 14
    s_add_u32 s34, s34, s28
    s_add_u32 s34, s34, 0x100000
    s_add_u32 m0, s27, 149504
    s_nop 0
    buffer_load_dwordx4 v18, s[60:63], s34 offen sc1 lds
    buffer_load_dwordx4 v19, s[60:63], s34 offen offset:1024 sc1 lds
L_x1:
    s_barrier
    s_cmp_eq_u32 s39, 1
    s_cbranch_scc1 L_x2
    s_mov_b32 s36, 0x40000
L_f3_poll:
    buffer_load_dwordx2 v[28:29], off, s[60:63], s38 sc1
    s_waitcnt vmcnt(0)
    v_xor_b32 v28, s42, v28
    v_xor_b32 v29, s42, v29
    v_or_b32 v28, v28, v29
    v_cmp_eq_u32 vcc, 0, v28
    s_nop 3
    s_cmp_eq_u64 vcc, exec
    s_cbranch_scc1 L_f3_got
    s_sub_u32 s36, s36, 1
    s_cmp_eq_u32 s36, 0
    s_cbranch_scc1 L_f3_got
    s_sleep 1
    s_branch L_f3_poll
L_f3_got:
    s_lshl_b32 s26, s25, 9
    s_add_u32 s26, s26, 0x10000
    s_mov_b32 m0, 147456
    s_lshl_b32 s28, s24, 9
    buffer_load_dwordx4 v14, s[60:63], s26 offen sc1 lds
    s_and_b32 s26, s23, 1
    s_lshl_b32 s26, s26, 8
    s_add_u32 s28, s28, s26
    s_add_u32 s28, s28, 0x30000
    s_add_u32 m0, s26, 148480
    s_lshl_b32 s31, s24, 1
    buffer_load_dword v20, s[60:63], s28 offen sc1 lds
    s_add_u32 s31, s31, s46
    s_lshl_b32 s31, s31, 8
    s_add_u32 s31, s31, 0x20000
    s_mov_b32 m0, 157696
    s_mul_i32 s34, s24, 114944
    buffer_load_dword v20, s[60:63], s31 offen sc1 lds
    s_lshl_b32 s28, s46, 7
    s_add_u32 s34, s34, s28
    s_lshl_b32 s28, s47, 14
    s_add_u32 s34, s34, s28
    s_add_u32 s34, s34, 0x100000
    s_add_u32 m0, s27, 149504
    s_nop 0
    buffer_load_dwordx4 v18, s[60:63], s34 offen sc1 lds
    buffer_load_dwordx4 v19, s[60:63], s34 offen offset:1024 sc1 lds
L_x2:
    buffer_load_dwordx4 v[168:171], v16, s[12:15], s35 offen
    s_add_u32 s35, s35, 7168
    buffer_load_dwordx4 v[172:175], v16, s[12:15], s35 offen
    s_add_u32 s35, s35, 0x16c00
    s_cmp_eq_u32 s35, 0x188000
    s_cselect_b32 s35, 0, s35
    buffer_load_dwordx4 v[176:179], v16, s[12:15], s35 offen
    s_add_u32 s35, s35, 7168
    buffer_load_dwordx4 v[180:183], v16, s[12:15], s35 offen
    s_add_u32 s35, s35, 7168
    buffer_load_dwordx4 v[184:187], v16, s[12:15], s35 offen
    s_add_u32 s35, s35, 7168
    buffer_load_dwordx4 v[188:191], v16, s[12:15], s35 offen
    s_add_u32 s35, s35, 0x16c00
    s_cmp_eq_u32 s35, 0x188000
    s_cselect_b32 s35, 0, s35
    buffer_load_dwordx4 v[192:195], v16, s[12:15], s35 offen
    s_add_u32 s35, s35, 7168
    buffer_load_dwordx4 v[196:199], v16, s[12:15], s35 offen
    s_add_u32 s35, s35, 7168
    buffer_load_dwordx4 v[200:203], v16, s[12:15], s35 offen
    s_add_u32 s35, s35, 7168
    buffer_load_dwordx4 v[204:207], v16, s[12:15], s35 offen
    s_add_u32 s35, s35, 0x16c00
    s_cmp_eq_u32 s35, 0x188000
    s_cselect_b32 s35, 0, s35
    buffer_load_dwordx4 v[208:211], v16, s[12:15], s35 offen
    s_add_u32 s35, s35, 7168
    buffer_load_dwordx4 v[212:215], v16, s[12:15], s35 offen
    s_add_u32 s35, s35, 7168
    s_waitcnt vmcnt(12)
    s_barrier
    buffer_load_dwordx4 v[216:219], v16, s[12:15], s35 offen
    s_add_u32 s35, s35, 7168
    buffer_load_dwordx4 v[220:223], v16, s[12:15], s35 offen
    s_add_u32 s35, s35, 0x16c00
    s_cmp_eq_u32 s35, 0x188000
    s_cselect_b32 s35, 0, s35
    buffer_load_dwordx4 v[224:227], v16, s[12:15], s35 offen
    s_add_u32 s35, s35, 7168
    buffer_load_dwordx4 v[228:231], v16, s[12:15], s35 offen
    s_add_u32 s35, s35, 7168
    buffer_load_dwordx4 v[232:235], v16, s[12:15], s35 offen
    s_add_u32 s35, s35, 7168
    buffer_load_dwordx4 v[236:239], v16, s[12:15], s35 offen
    s_add_u32 s35, s35, 0x16c00
    s_cmp_eq_u32 s35, 0x188000
    s_cselect_b32 s35, 0, s35
    buffer_load_dwordx4 v[240:243], v16, s[12:15], s35 offen
    s_add_u32 s35, s35, 7168
    buffer_load_dwordx4 v[244:247], v16, s[12:15], s35 offen
    s_add_u32 s35, s35, 7168
    buffer_load_dwordx4 v[248:251], v16, s[12:15], s35 offen
    s_add_u32 s35, s35, 7168
    buffer_load_dwordx4 v[252:255], v16, s[12:15], s35 offen
    s_add_u32 s35, s35, 0x16c00
    s_cmp_eq_u32 s35, 0x188000
    s_cselect_b32 s35, 0, s35
    s_setprio 0
    s_barrier
    ds_write_b128 v24, v[32:35] offset:0
    ds_write_b128 v24, v[36:39] offset:1024
    ds_write_b128 v24, v[40:43] offset:2048
    ds_write_b128 v24, v[44:47] offset:3072
    ds_write_b128 v24, v[48:51] offset:16384
    ds_write_b128 v24, v[52:55] offset:17408
    ds_write_b128 v24, v[56:59] offset:18432
    ds_write_b128 v24, v[60:63] offset:19456
    ds_write_b128 v24, v[64:67] offset:32768
    ds_write_b128 v24, v[68:71] offset:33792
    ds_write_b128 v24, v[72:75] offset:34816
    ds_write_b128 v24, v[76:79] offset:35840
    ds_write_b128 v24, v[80:83] offset:49152
    ds_write_b128 v24, v[84:87] offset:50176
    ds_write_b128 v24, v[88:91] offset:51200
    ds_write_b128 v24, v[92:95] offset:52224
    ds_write_b128 v25, v[96:99] offset:0
    ds_write_b128 v25, v[100:103] offset:1024
    ds_write_b128 v25, v[104:107] offset:2048
    ds_write_b128 v25, v[108:111] offset:3072
    ds_write_b128 v25, v[112:115] offset:16384
    ds_write_b128 v25, v[116:119] offset:17408
    ds_write_b128 v25, v[120:123] offset:18432
    ds_write_b128 v25, v[124:127] offset:19456
    ds_write_b128 v25, v[128:131] offset:32768
    ds_write_b128 v25, v[132:135] offset:33792
    ds_write_b128 v25, v[136:139] offset:34816
    ds_write_b128 v25, v[140:143] offset:35840
    ds_write_b128 v25, v[144:147] offset:49152
    ds_write_b128 v25, v[148:151] offset:50176
    ds_write_b128 v25, v[152:155] offset:51200
    ds_write_b128 v25, v[156:159] offset:52224
    s_waitcnt vmcnt(20)
    ds_write_b128 v26, v[160:163] offset:0
    ds_write_b128 v26, v[164:167] offset:1024
    ds_write_b128 v26, v[168:171] offset:2048
    ds_write_b128 v26, v[172:175] offset:3072
    s_waitcnt vmcnt(0) lgkmcnt(0)
    s_barrier
    s_barrier
    ds_write_b128 v24, v[176:179] offset:0
    ds_write_b128 v24, v[180:183] offset:1024
    ds_write_b128 v24, v[184:187] offset:2048
    ds_write_b128 v24, v[188:191] offset:3072
    ds_write_b128 v24, v[192:195] offset:16384
    ds_write_b128 v24, v[196:199] offset:17408
    ds_write_b128 v24, v[200:203] offset:18432
    ds_write_b128 v24, v[204:207] offset:19456
    ds_write_b128 v24, v[208:211] offset:32768
    ds_write_b128 v24, v[212:215] offset:33792
    ds_write_b128 v24, v[216:219] offset:34816
    ds_write_b128 v24, v[220:223] offset:35840
    ds_write_b128 v24, v[224:227] offset:49152
    ds_write_b128 v24, v[228:231] offset:50176
    ds_write_b128 v24, v[232:235] offset:51200
    ds_write_b128 v24, v[236:239] offset:52224
    ds_write_b128 v25, v[240:243] offset:0
    ds_write_b128 v25, v[244:247] offset:1024
    ds_write_b128 v25, v[248:251] offset:2048
    ds_write_b128 v25, v[252:255] offset:3072
    s_waitcnt lgkmcnt(0)
    s_barrier
    s_barrier
    s_barrier
    s_endpgm
AUX:
    s_mov_b32 s26, 0x3f803f80
    v_mov_b32 v104, 0
    v_mov_b32 v105, 0
    s_mul_i32 s27, s22, 928
    s_add_u32 s27, s27, 122880
    v_lshl_add_u32 v116, v2, 4, s27
    v_bfe_u32 v117, v2, 2, 2
    v_mul_u32_u24 v117, 928, v117
    v_and_b32 v118, 3, v2
    v_lshl_add_u32 v117, v118, 3, v117
    v_lshrrev_b32 v118, 4, v2
    v_lshl_add_u32 v117, v118, 5, v117
    s_min_u32 s34, s22, 6
    s_lshl_b32 s27, s34, 7
    s_add_u32 s27, s27, 122880
    v_add_u32 v117, s27, v117
    v_lshrrev_b32 v118, 3, v2
    v_mul_u32_u24 v118, 33024, v118
    v_and_b32 v119, 7, v2
    v_lshl_add_u32 v118, v119, 4, v118
    s_mul_i32 s34, s34, 264192
    s_lshl_b32 s35, s2, 7
    s_add_u32 s34, s34, s35
    s_add_u32 s34, s34, 0x800000
    s_lshl_b32 s35, s2, 6
    s_add_u32 s35, s35, 0x4000
    s_lshl_b32 s27, s22, 2
    s_add_u32 s27, s27, 130560
    v_lshl_add_u32 v119, v2, 5, s27
    v_lshlrev_b32 v115, 4, v2
    s_waitcnt vmcnt(1)
    s_mov_b64 exec, s[32:33]
    ds_write_b128 v116, v[96:99]
    s_mov_b64 exec, -1
    v_dot2c_f32_bf16 v104, s26, v96
    v_dot2c_f32_bf16 v105, v96, v96
    v_dot2c_f32_bf16 v104, s26, v97
    v_dot2c_f32_bf16 v105, v97, v97
    v_dot2c_f32_bf16 v104, s26, v98
    v_dot2c_f32_bf16 v105, v98, v98
    v_dot2c_f32_bf16 v104, s26, v99
    v_dot2c_f32_bf16 v105, v99, v99
    s_waitcnt lgkmcnt(0)
    s_barrier
    ds_read_b64_tr_b16 v[100:101], v117
    ds_read_b64_tr_b16 v[102:103], v117 offset:3712
    s_nop 0
    v_add_f32_dpp v104, v104, v104 quad_perm:[1,0,3,2] row_mask:0xf bank_mask:0xf
    v_add_f32_dpp v105, v105, v105 quad_perm:[1,0,3,2] row_mask:0xf bank_mask:0xf
    s_nop 0
    v_add_f32_dpp v104, v104, v104 quad_perm:[2,3,0,1] row_mask:0xf bank_mask:0xf
    v_add_f32_dpp v105, v105, v105 quad_perm:[2,3,0,1] row_mask:0xf bank_mask:0xf
    s_nop 0
    v_add_f32_dpp v104, v104, v104 row_half_mirror row_mask:0xf bank_mask:0xf
    v_add_f32_dpp v105, v105, v105 row_half_mirror row_mask:0xf bank_mask:0xf
    s_nop 0
    v_add_f32_dpp v104, v104, v104 row_mirror row_mask:0xf bank_mask:0xf
    v_add_f32_dpp v105, v105, v105 row_mirror row_mask:0xf bank_mask:0xf
    s_waitcnt lgkmcnt(0)
    s_cmp_eq_u32 s22, 7
    s_cbranch_scc1 P0_a0
    buffer_store_dwordx4 v[100:103], v118, s[60:63], s34 offen sc1
    P0_a0:
    v_mov_b32 v120, v104
    v_mov_b32 v121, v105
    s_nop 1
    v_permlane16_swap_b32 v104, v120
    v_permlane16_swap_b32 v105, v121
    v_add_f32 v104, v104, v120
    v_add_f32 v105, v105, v121
    v_mov_b32 v120, v104
    v_mov_b32 v121, v105
    s_nop 1
    v_permlane32_swap_b32 v104, v120
    v_permlane32_swap_b32 v105, v121
    v_add_f32 v104, v104, v120
    v_add_f32 v105, v105, v121
    v_mul_f32 v104, 0x3b124925, v104
    v_mul_f32 v105, 0x3b124925, v105
    v_fma_f32 v105, -v104, v104, v105
    v_cvt_pk_bf16_f32 v120, v104, v104
    v_lshlrev_b32 v120, 16, v120
    v_max_f32 v105, 0, v105
    v_cvt_pk_bf16_f32 v105, v105, v105
    v_lshlrev_b32 v105, 16, v105
    v_add_f32 v105, 0x3727c5ac, v105
    v_cvt_pk_bf16_f32 v105, v105, v105
    v_lshlrev_b32 v105, 16, v105
    v_sqrt_f32 v105, v105
    s_nop 0
    v_cvt_pk_bf16_f32 v105, v105, v105
    v_lshlrev_b32 v105, 16, v105
    v_rcp_f32 v121, v105
    v_cmp_eq_u32 vcc, 0, v2
    s_mov_b64 exec, 3
    s_nop 0
    v_cndmask_b32 v120, v121, v120, vcc
    ds_write_b32 v119, v120
    s_mov_b64 exec, -1
    s_waitcnt lgkmcnt(0)
    s_barrier
    s_cmp_lg_u32 s22, 7
    s_cbranch_scc1 P0_b0
    s_mov_b64 exec, 15
    v_add_u32 v114, 130560, v115
    ds_read_b128 v[100:103], v114
    s_waitcnt lgkmcnt(0)
    buffer_store_dwordx4 v[100:103], v115, s[60:63], s35 offen sc1
    s_mov_b64 exec, -1
P0_b0:
    s_waitcnt vmcnt(0)
    v_readfirstlane_b32 s41, v126
    s_barrier
    s_mul_i32 s42, s41, 0x9e3779b1
    s_add_u32 s42, s42, 0x7f4a7c15
    s_cmp_lg_u32 s22, 0
    s_cbranch_scc1 AUX_f1
    s_lshr_b32 s28, s2, 2
    s_lshl_b32 s28, s28, 7
    s_and_b32 s32, s2, 3
    s_lshl_b32 s32, s32, 2
    s_add_u32 s28, s28, s32
    s_add_u32 s28, s28, 0x40000
    v_mul_u32_u24 v1, 8320, v2
    v_mov_b32 v3, s42
    s_mov_b64 exec, 15
    buffer_store_dword v3, v1, s[60:63], s28 offen sc1
    s_mov_b64 exec, -1
AUX_f1:
    v_min_u32 v7, 447, v0
    v_mul_u32_u24 v1, 0x124a, v7
    v_lshrrev_b32 v1, 16, v1
    v_mul_u32_u24 v2, 14, v1
    v_sub_u32 v2, v7, v2
    v_mul_u32_u24 v3, 3584, v1
    v_lshl_add_u32 v3, v2, 4, v3
    s_and_b32 s26, s2, 15
    s_mul_i32 s12, s26, 224
    s_cmp_ge_u32 s2, 16
    s_cselect_b32 s4, s50, s48
    s_cselect_b32 s5, s51, s49
    s_mov_b32 s8, s4
    s_mov_b32 s9, s5
    s_mov_b32 s10, 0x188000
    s_mov_b32 s11, 0x00020000
    buffer_load_dwordx4 v[8:11], v3, s[8:11], s12 offen
    s_add_u32 s12, s12, 0x1c000
    buffer_load_dwordx4 v[12:15], v3, s[8:11], s12 offen
    s_add_u32 s12, s12, 0x1c000
    buffer_load_dwordx4 v[16:19], v3, s[8:11], s12 offen
    s_add_u32 s12, s12, 0x1c000
    buffer_load_dwordx4 v[20:23], v3, s[8:11], s12 offen
    s_add_u32 s12, s12, 0x1c000
    buffer_load_dwordx4 v[24:27], v3, s[8:11], s12 offen
    s_add_u32 s12, s12, 0x1c000
    buffer_load_dwordx4 v[28:31], v3, s[8:11], s12 offen
    s_add_u32 s12, s12, 0x1c000
    buffer_load_dwordx4 v[32:35], v3, s[8:11], s12 offen
    s_add_u32 s12, s12, 0x1c000
    buffer_load_dwordx4 v[36:39], v3, s[8:11], s12 offen
    s_add_u32 s12, s12, 0x1c000
    buffer_load_dwordx4 v[40:43], v3, s[8:11], s12 offen
    s_add_u32 s12, s12, 0x1c000
    buffer_load_dwordx4 v[44:47], v3, s[8:11], s12 offen
    s_add_u32 s12, s12, 0x1c000
    buffer_load_dwordx4 v[48:51], v3, s[8:11], s12 offen
    s_add_u32 s12, s12, 0x1c000
    buffer_load_dwordx4 v[52:55], v3, s[8:11], s12 offen
    s_add_u32 s12, s12, 0x1c000
    buffer_load_dwordx4 v[56:59], v3, s[8:11], s12 offen
    s_add_u32 s12, s12, 0x1c000
    buffer_load_dwordx4 v[60:63], v3, s[8:11], s12 offen
    v_mov_b32 v64, 0
    v_mov_b32 v65, 0
    v_mov_b32 v66, 0
    v_mov_b32 v67, 0
    v_mov_b32 v68, 0
    v_mov_b32 v69, 0
    v_mov_b32 v70, 0
    v_mov_b32 v71, 0
    s_waitcnt vmcnt(13)
    v_lshlrev_b32 v72, 16, v8
    v_and_b32 v73, 0xffff0000, v8
    v_pk_add_f32 v[64:65], v[64:65], v[72:73]
    v_lshlrev_b32 v72, 16, v9
    v_and_b32 v73, 0xffff0000, v9
    v_pk_add_f32 v[66:67], v[66:67], v[72:73]
    v_lshlrev_b32 v72, 16, v10
    v_and_b32 v73, 0xffff0000, v10
    v_pk_add_f32 v[68:69], v[68:69], v[72:73]
    v_lshlrev_b32 v72, 16, v11
    v_and_b32 v73, 0xffff0000, v11
    v_pk_add_f32 v[70:71], v[70:71], v[72:73]
    s_waitcnt vmcnt(12)
    v_lshlrev_b32 v72, 16, v12
    v_and_b32 v73, 0xffff0000, v12
    v_pk_add_f32 v[64:65], v[64:65], v[72:73]
    v_lshlrev_b32 v72, 16, v13
    v_and_b32 v73, 0xffff0000, v13
    v_pk_add_f32 v[66:67], v[66:67], v[72:73]
    v_lshlrev_b32 v72, 16, v14
    v_and_b32 v73, 0xffff0000, v14
    v_pk_add_f32 v[68:69], v[68:69], v[72:73]
    v_lshlrev_b32 v72, 16, v15
    v_and_b32 v73, 0xffff0000, v15
    v_pk_add_f32 v[70:71], v[70:71], v[72:73]
    s_waitcnt vmcnt(11)
    v_lshlrev_b32 v72, 16, v16
    v_and_b32 v73, 0xffff0000, v16
    v_pk_add_f32 v[64:65], v[64:65], v[72:73]
    v_lshlrev_b32 v72, 16, v17
    v_and_b32 v73, 0xffff0000, v17
    v_pk_add_f32 v[66:67], v[66:67], v[72:73]
    v_lshlrev_b32 v72, 16, v18
    v_and_b32 v73, 0xffff0000, v18
    v_pk_add_f32 v[68:69], v[68:69], v[72:73]
    v_lshlrev_b32 v72, 16, v19
    v_and_b32 v73, 0xffff0000, v19
    v_pk_add_f32 v[70:71], v[70:71], v[72:73]
    s_waitcnt vmcnt(10)
    v_lshlrev_b32 v72, 16, v20
    v_and_b32 v73, 0xffff0000, v20
    v_pk_add_f32 v[64:65], v[64:65], v[72:73]
    v_lshlrev_b32 v72, 16, v21
    v_and_b32 v73, 0xffff0000, v21
    v_pk_add_f32 v[66:67], v[66:67], v[72:73]
    v_lshlrev_b32 v72, 16, v22
    v_and_b32 v73, 0xffff0000, v22
    v_pk_add_f32 v[68:69], v[68:69], v[72:73]
    v_lshlrev_b32 v72, 16, v23
    v_and_b32 v73, 0xffff0000, v23
    v_pk_add_f32 v[70:71], v[70:71], v[72:73]
    s_waitcnt vmcnt(9)
    v_lshlrev_b32 v72, 16, v24
    v_and_b32 v73, 0xffff0000, v24
    v_pk_add_f32 v[64:65], v[64:65], v[72:73]
    v_lshlrev_b32 v72, 16, v25
    v_and_b32 v73, 0xffff0000, v25
    v_pk_add_f32 v[66:67], v[66:67], v[72:73]
    v_lshlrev_b32 v72, 16, v26
    v_and_b32 v73, 0xffff0000, v26
    v_pk_add_f32 v[68:69], v[68:69], v[72:73]
    v_lshlrev_b32 v72, 16, v27
    v_and_b32 v73, 0xffff0000, v27
    v_pk_add_f32 v[70:71], v[70:71], v[72:73]
    s_waitcnt vmcnt(8)
    v_lshlrev_b32 v72, 16, v28
    v_and_b32 v73, 0xffff0000, v28
    v_pk_add_f32 v[64:65], v[64:65], v[72:73]
    v_lshlrev_b32 v72, 16, v29
    v_and_b32 v73, 0xffff0000, v29
    v_pk_add_f32 v[66:67], v[66:67], v[72:73]
    v_lshlrev_b32 v72, 16, v30
    v_and_b32 v73, 0xffff0000, v30
    v_pk_add_f32 v[68:69], v[68:69], v[72:73]
    v_lshlrev_b32 v72, 16, v31
    v_and_b32 v73, 0xffff0000, v31
    v_pk_add_f32 v[70:71], v[70:71], v[72:73]
    s_waitcnt vmcnt(7)
    v_lshlrev_b32 v72, 16, v32
    v_and_b32 v73, 0xffff0000, v32
    v_pk_add_f32 v[64:65], v[64:65], v[72:73]
    v_lshlrev_b32 v72, 16, v33
    v_and_b32 v73, 0xffff0000, v33
    v_pk_add_f32 v[66:67], v[66:67], v[72:73]
    v_lshlrev_b32 v72, 16, v34
    v_and_b32 v73, 0xffff0000, v34
    v_pk_add_f32 v[68:69], v[68:69], v[72:73]
    v_lshlrev_b32 v72, 16, v35
    v_and_b32 v73, 0xffff0000, v35
    v_pk_add_f32 v[70:71], v[70:71], v[72:73]
    s_waitcnt vmcnt(6)
    v_lshlrev_b32 v72, 16, v36
    v_and_b32 v73, 0xffff0000, v36
    v_pk_add_f32 v[64:65], v[64:65], v[72:73]
    v_lshlrev_b32 v72, 16, v37
    v_and_b32 v73, 0xffff0000, v37
    v_pk_add_f32 v[66:67], v[66:67], v[72:73]
    v_lshlrev_b32 v72, 16, v38
    v_and_b32 v73, 0xffff0000, v38
    v_pk_add_f32 v[68:69], v[68:69], v[72:73]
    v_lshlrev_b32 v72, 16, v39
    v_and_b32 v73, 0xffff0000, v39
    v_pk_add_f32 v[70:71], v[70:71], v[72:73]
    s_waitcnt vmcnt(5)
    v_lshlrev_b32 v72, 16, v40
    v_and_b32 v73, 0xffff0000, v40
    v_pk_add_f32 v[64:65], v[64:65], v[72:73]
    v_lshlrev_b32 v72, 16, v41
    v_and_b32 v73, 0xffff0000, v41
    v_pk_add_f32 v[66:67], v[66:67], v[72:73]
    v_lshlrev_b32 v72, 16, v42
    v_and_b32 v73, 0xffff0000, v42
    v_pk_add_f32 v[68:69], v[68:69], v[72:73]
    v_lshlrev_b32 v72, 16, v43
    v_and_b32 v73, 0xffff0000, v43
    v_pk_add_f32 v[70:71], v[70:71], v[72:73]
    s_waitcnt vmcnt(4)
    v_lshlrev_b32 v72, 16, v44
    v_and_b32 v73, 0xffff0000, v44
    v_pk_add_f32 v[64:65], v[64:65], v[72:73]
    v_lshlrev_b32 v72, 16, v45
    v_and_b32 v73, 0xffff0000, v45
    v_pk_add_f32 v[66:67], v[66:67], v[72:73]
    v_lshlrev_b32 v72, 16, v46
    v_and_b32 v73, 0xffff0000, v46
    v_pk_add_f32 v[68:69], v[68:69], v[72:73]
    v_lshlrev_b32 v72, 16, v47
    v_and_b32 v73, 0xffff0000, v47
    v_pk_add_f32 v[70:71], v[70:71], v[72:73]
    s_waitcnt vmcnt(3)
    v_lshlrev_b32 v72, 16, v48
    v_and_b32 v73, 0xffff0000, v48
    v_pk_add_f32 v[64:65], v[64:65], v[72:73]
    v_lshlrev_b32 v72, 16, v49
    v_and_b32 v73, 0xffff0000, v49
    v_pk_add_f32 v[66:67], v[66:67], v[72:73]
    v_lshlrev_b32 v72, 16, v50
    v_and_b32 v73, 0xffff0000, v50
    v_pk_add_f32 v[68:69], v[68:69], v[72:73]
    v_lshlrev_b32 v72, 16, v51
    v_and_b32 v73, 0xffff0000, v51
    v_pk_add_f32 v[70:71], v[70:71], v[72:73]
    s_waitcnt vmcnt(2)
    v_lshlrev_b32 v72, 16, v52
    v_and_b32 v73, 0xffff0000, v52
    v_pk_add_f32 v[64:65], v[64:65], v[72:73]
    v_lshlrev_b32 v72, 16, v53
    v_and_b32 v73, 0xffff0000, v53
    v_pk_add_f32 v[66:67], v[66:67], v[72:73]
    v_lshlrev_b32 v72, 16, v54
    v_and_b32 v73, 0xffff0000, v54
    v_pk_add_f32 v[68:69], v[68:69], v[72:73]
    v_lshlrev_b32 v72, 16, v55
    v_and_b32 v73, 0xffff0000, v55
    v_pk_add_f32 v[70:71], v[70:71], v[72:73]
    s_waitcnt vmcnt(1)
    v_lshlrev_b32 v72, 16, v56
    v_and_b32 v73, 0xffff0000, v56
    v_pk_add_f32 v[64:65], v[64:65], v[72:73]
    v_lshlrev_b32 v72, 16, v57
    v_and_b32 v73, 0xffff0000, v57
    v_pk_add_f32 v[66:67], v[66:67], v[72:73]
    v_lshlrev_b32 v72, 16, v58
    v_and_b32 v73, 0xffff0000, v58
    v_pk_add_f32 v[68:69], v[68:69], v[72:73]
    v_lshlrev_b32 v72, 16, v59
    v_and_b32 v73, 0xffff0000, v59
    v_pk_add_f32 v[70:71], v[70:71], v[72:73]
    s_waitcnt vmcnt(0)
    v_lshlrev_b32 v72, 16, v60
    v_and_b32 v73, 0xffff0000, v60
    v_pk_add_f32 v[64:65], v[64:65], v[72:73]
    v_lshlrev_b32 v72, 16, v61
    v_and_b32 v73, 0xffff0000, v61
    v_pk_add_f32 v[66:67], v[66:67], v[72:73]
    v_lshlrev_b32 v72, 16, v62
    v_and_b32 v73, 0xffff0000, v62
    v_pk_add_f32 v[68:69], v[68:69], v[72:73]
    v_lshlrev_b32 v72, 16, v63
    v_and_b32 v73, 0xffff0000, v63
    v_pk_add_f32 v[70:71], v[70:71], v[72:73]
    v_mul_u32_u24 v4, 464, v1
    v_lshl_add_u32 v4, v2, 5, v4
    ds_write_b128 v4, v[64:67]
    ds_write_b128 v4, v[68:71] offset:16
    v_and_b32 v5, 127, v0
    v_min_u32 v5, 111, v5
    v_lshrrev_b32 v6, 7, v0
    v_mul_u32_u24 v7, 3712, v6
    v_lshl_add_u32 v7, v5, 2, v7
    s_waitcnt lgkmcnt(0)
    s_barrier
    ds_read_b32 v8, v7 offset:0
    ds_read_b32 v9, v7 offset:464
    ds_read_b32 v10, v7 offset:928
    ds_read_b32 v11, v7 offset:1392
    ds_read_b32 v12, v7 offset:1856
    ds_read_b32 v13, v7 offset:2320
    ds_read_b32 v14, v7 offset:2784
    ds_read_b32 v15, v7 offset:3248
    s_waitcnt lgkmcnt(0)
    v_add_f32 v8, v8, v12
    v_add_f32 v9, v9, v13
    v_add_f32 v10, v10, v14
    v_add_f32 v11, v11, v15
    v_add_f32 v8, v8, v10
    v_add_f32 v9, v9, v11
    v_add_f32 v8, v8, v9
    v_lshlrev_b32 v7, 9, v6
    v_lshl_add_u32 v7, v5, 2, v7
    ds_write_b32 v7, v8 offset:16384
    v_lshlrev_b32 v7, 2, v5
    s_waitcnt lgkmcnt(0)
    s_barrier
    ds_read_b32 v8, v7 offset:16384
    ds_read_b32 v9, v7 offset:16896
    ds_read_b32 v10, v7 offset:17408
    ds_read_b32 v11, v7 offset:17920
    s_mul_i32 s12, s2, 448
    s_add_u32 s12, s12, 0x10000
    s_waitcnt lgkmcnt(0)
    v_add_f32 v8, v8, v9
    v_add_f32 v10, v10, v11
    v_add_f32 v8, v8, v10
    v_cmp_gt_u32 vcc, 112, v0
    s_and_saveexec_b64 s[32:33], vcc
    s_cbranch_execz AUX_c
    buffer_store_dword v8, v7, s[60:63], s12 offen sc1
AUX_c:
    s_mov_b64 exec, s[32:33]
    v_and_b32 v2, 63, v0
    v_lshlrev_b32 v5, 7, v2
    s_and_b32 s28, s2, 3
    s_mul_i32 s28, s28, 8320
    s_add_u32 s29, s28, 0x50000
    s_waitcnt vmcnt(0)
    s_barrier
    s_cmp_lg_u32 s22, 0
    s_cbranch_scc1 AUX_w
    s_lshr_b32 s28, s2, 2
    s_lshl_b32 s28, s28, 7
    s_and_b32 s32, s2, 3
    s_lshl_b32 s32, s32, 2
    s_add_u32 s28, s28, s32
    s_add_u32 s28, s28, 0x50000
    v_mul_u32_u24 v1, 8320, v2
    v_mov_b32 v3, s42
    s_mov_b64 exec, 15
    buffer_store_dword v3, v1, s[60:63], s28 offen sc1
    s_mov_b64 exec, -1
    s_mov_b32 s36, 0x40000
AUX_p2_poll:
    buffer_load_dwordx4 v[8:11], v5, s[60:63], s29 offen sc1
    s_waitcnt vmcnt(0)
    v_xor_b32 v8, s42, v8
    v_xor_b32 v9, s42, v9
    v_xor_b32 v10, s42, v10
    v_xor_b32 v11, s42, v11
    v_or3_b32 v8, v8, v9, v10
    v_or_b32 v8, v8, v11
    v_cmp_eq_u32 vcc, 0, v8
    s_nop 3
    s_cmp_eq_u64 vcc, exec
    s_cbranch_scc1 AUX_p2_got
    s_sub_u32 s36, s36, 1
    s_cmp_eq_u32 s36, 0
    s_cbranch_scc1 AUX_p2_got
    s_sleep 4
    s_branch AUX_p2_poll
AUX_p2_got:
    s_cmp_lg_u32 s2, 0
    s_cbranch_scc1 AUX_w
    s_add_u32 s26, s41, 1
    v_mov_b32 v8, s26
    s_mov_b64 exec, 1
    buffer_store_dword v8, off, s[60:63], 0 sc1
    s_mov_b64 exec, -1
AUX_w:
    s_waitcnt vmcnt(0)
    s_barrier
    v_lshrrev_b32 v1, 3, v0
    v_and_b32 v2, 7, v0
    v_lshlrev_b32 v3, 8, v1
    v_lshl_add_u32 v3, v2, 4, v3
    s_lshr_b32 s24, s2, 1
    s_mul_i32 s24, s24, 114944
    s_and_b32 s25, s2, 1
    s_lshl_b32 s25, s25, 7
    s_add_u32 s24, s24, s25
    s_add_u32 s24, s24, 0x100000
    buffer_load_dwordx4 v[8:11], v3, s[60:63], s24 offen sc1
    s_add_u32 s24, s24, 16384
    buffer_load_dwordx4 v[12:15], v3, s[60:63], s24 offen sc1
    s_add_u32 s24, s24, 16384
    buffer_load_dwordx4 v[16:19], v3, s[60:63], s24 offen sc1
    s_add_u32 s24, s24, 16384
    buffer_load_dwordx4 v[20:23], v3, s[60:63], s24 offen sc1
    s_add_u32 s24, s24, 16384
    buffer_load_dwordx4 v[24:27], v3, s[60:63], s24 offen sc1
    s_add_u32 s24, s24, 16384
    buffer_load_dwordx4 v[28:31], v3, s[60:63], s24 offen sc1
    s_add_u32 s24, s24, 16384
    buffer_load_dwordx4 v[32:35], v3, s[60:63], s24 offen sc1
    v_mov_b32 v40, 0
    v_mov_b32 v41, 0
    v_mov_b32 v42, 0
    v_mov_b32 v43, 0
    v_mov_b32 v44, 0
    v_mov_b32 v45, 0
    v_mov_b32 v46, 0
    v_mov_b32 v47, 0
    v_mov_b32 v48, 0
    v_mov_b32 v49, 0
    v_mov_b32 v50, 0
    v_mov_b32 v51, 0
    v_mov_b32 v52, 0
    v_mov_b32 v53, 0
    v_mov_b32 v54, 0
    v_mov_b32 v55, 0
    s_waitcnt vmcnt(6)
    v_lshlrev_b32 v56, 16, v8
    v_and_b32 v57, 0xffff0000, v8
    v_pk_add_f32 v[40:41], v[40:41], v[56:57]
    v_pk_fma_f32 v[48:49], v[56:57], v[56:57], v[48:49]
    v_lshlrev_b32 v56, 16, v9
    v_and_b32 v57, 0xffff0000, v9
    v_pk_add_f32 v[42:43], v[42:43], v[56:57]
    v_pk_fma_f32 v[50:51], v[56:57], v[56:57], v[50:51]
    v_lshlrev_b32 v56, 16, v10
    v_and_b32 v57, 0xffff0000, v10
    v_pk_add_f32 v[44:45], v[44:45], v[56:57]
    v_pk_fma_f32 v[52:53], v[56:57], v[56:57], v[52:53]
    v_lshlrev_b32 v56, 16, v11
    v_and_b32 v57, 0xffff0000, v11
    v_pk_add_f32 v[46:47], v[46:47], v[56:57]
    v_pk_fma_f32 v[54:55], v[56:57], v[56:57], v[54:55]
    s_waitcnt vmcnt(5)
    v_lshlrev_b32 v56, 16, v12
    v_and_b32 v57, 0xffff0000, v12
    v_pk_add_f32 v[40:41], v[40:41], v[56:57]
    v_pk_fma_f32 v[48:49], v[56:57], v[56:57], v[48:49]
    v_lshlrev_b32 v56, 16, v13
    v_and_b32 v57, 0xffff0000, v13
    v_pk_add_f32 v[42:43], v[42:43], v[56:57]
    v_pk_fma_f32 v[50:51], v[56:57], v[56:57], v[50:51]
    v_lshlrev_b32 v56, 16, v14
    v_and_b32 v57, 0xffff0000, v14
    v_pk_add_f32 v[44:45], v[44:45], v[56:57]
    v_pk_fma_f32 v[52:53], v[56:57], v[56:57], v[52:53]
    v_lshlrev_b32 v56, 16, v15
    v_and_b32 v57, 0xffff0000, v15
    v_pk_add_f32 v[46:47], v[46:47], v[56:57]
    v_pk_fma_f32 v[54:55], v[56:57], v[56:57], v[54:55]
    s_waitcnt vmcnt(4)
    v_lshlrev_b32 v56, 16, v16
    v_and_b32 v57, 0xffff0000, v16
    v_pk_add_f32 v[40:41], v[40:41], v[56:57]
    v_pk_fma_f32 v[48:49], v[56:57], v[56:57], v[48:49]
    v_lshlrev_b32 v56, 16, v17
    v_and_b32 v57, 0xffff0000, v17
    v_pk_add_f32 v[42:43], v[42:43], v[56:57]
    v_pk_fma_f32 v[50:51], v[56:57], v[56:57], v[50:51]
    v_lshlrev_b32 v56, 16, v18
    v_and_b32 v57, 0xffff0000, v18
    v_pk_add_f32 v[44:45], v[44:45], v[56:57]
    v_pk_fma_f32 v[52:53], v[56:57], v[56:57], v[52:53]
    v_lshlrev_b32 v56, 16, v19
    v_and_b32 v57, 0xffff0000, v19
    v_pk_add_f32 v[46:47], v[46:47], v[56:57]
    v_pk_fma_f32 v[54:55], v[56:57], v[56:57], v[54:55]
    s_waitcnt vmcnt(3)
    v_lshlrev_b32 v56, 16, v20
    v_and_b32 v57, 0xffff0000, v20
    v_pk_add_f32 v[40:41], v[40:41], v[56:57]
    v_pk_fma_f32 v[48:49], v[56:57], v[56:57], v[48:49]
    v_lshlrev_b32 v56, 16, v21
    v_and_b32 v57, 0xffff0000, v21
    v_pk_add_f32 v[42:43], v[42:43], v[56:57]
    v_pk_fma_f32 v[50:51], v[56:57], v[56:57], v[50:51]
    v_lshlrev_b32 v56, 16, v22
    v_and_b32 v57, 0xffff0000, v22
    v_pk_add_f32 v[44:45], v[44:45], v[56:57]
    v_pk_fma_f32 v[52:53], v[56:57], v[56:57], v[52:53]
    v_lshlrev_b32 v56, 16, v23
    v_and_b32 v57, 0xffff0000, v23
    v_pk_add_f32 v[46:47], v[46:47], v[56:57]
    v_pk_fma_f32 v[54:55], v[56:57], v[56:57], v[54:55]
    s_waitcnt vmcnt(2)
    v_lshlrev_b32 v56, 16, v24
    v_and_b32 v57, 0xffff0000, v24
    v_pk_add_f32 v[40:41], v[40:41], v[56:57]
    v_pk_fma_f32 v[48:49], v[56:57], v[56:57], v[48:49]
    v_lshlrev_b32 v56, 16, v25
    v_and_b32 v57, 0xffff0000, v25
    v_pk_add_f32 v[42:43], v[42:43], v[56:57]
    v_pk_fma_f32 v[50:51], v[56:57], v[56:57], v[50:51]
    v_lshlrev_b32 v56, 16, v26
    v_and_b32 v57, 0xffff0000, v26
    v_pk_add_f32 v[44:45], v[44:45], v[56:57]
    v_pk_fma_f32 v[52:53], v[56:57], v[56:57], v[52:53]
    v_lshlrev_b32 v56, 16, v27
    v_and_b32 v57, 0xffff0000, v27
    v_pk_add_f32 v[46:47], v[46:47], v[56:57]
    v_pk_fma_f32 v[54:55], v[56:57], v[56:57], v[54:55]
    s_waitcnt vmcnt(1)
    v_lshlrev_b32 v56, 16, v28
    v_and_b32 v57, 0xffff0000, v28
    v_pk_add_f32 v[40:41], v[40:41], v[56:57]
    v_pk_fma_f32 v[48:49], v[56:57], v[56:57], v[48:49]
    v_lshlrev_b32 v56, 16, v29
    v_and_b32 v57, 0xffff0000, v29
    v_pk_add_f32 v[42:43], v[42:43], v[56:57]
    v_pk_fma_f32 v[50:51], v[56:57], v[56:57], v[50:51]
    v_lshlrev_b32 v56, 16, v30
    v_and_b32 v57, 0xffff0000, v30
    v_pk_add_f32 v[44:45], v[44:45], v[56:57]
    v_pk_fma_f32 v[52:53], v[56:57], v[56:57], v[52:53]
    v_lshlrev_b32 v56, 16, v31
    v_and_b32 v57, 0xffff0000, v31
    v_pk_add_f32 v[46:47], v[46:47], v[56:57]
    v_pk_fma_f32 v[54:55], v[56:57], v[56:57], v[54:55]
    s_waitcnt vmcnt(0)
    v_lshlrev_b32 v56, 16, v32
    v_and_b32 v57, 0xffff0000, v32
    v_pk_add_f32 v[40:41], v[40:41], v[56:57]
    v_pk_fma_f32 v[48:49], v[56:57], v[56:57], v[48:49]
    v_lshlrev_b32 v56, 16, v33
    v_and_b32 v57, 0xffff0000, v33
    v_pk_add_f32 v[42:43], v[42:43], v[56:57]
    v_pk_fma_f32 v[50:51], v[56:57], v[56:57], v[50:51]
    v_lshlrev_b32 v56, 16, v34
    v_and_b32 v57, 0xffff0000, v34
    v_pk_add_f32 v[44:45], v[44:45], v[56:57]
    v_pk_fma_f32 v[52:53], v[56:57], v[56:57], v[52:53]
    v_lshlrev_b32 v56, 16, v35
    v_and_b32 v57, 0xffff0000, v35
    v_pk_add_f32 v[46:47], v[46:47], v[56:57]
    v_pk_fma_f32 v[54:55], v[56:57], v[56:57], v[54:55]
    v_mul_u32_u24 v4, 528, v1
    v_lshl_add_u32 v4, v2, 5, v4
    ds_write_b128 v4, v[40:43]
    ds_write_b128 v4, v[44:47] offset:16
    ds_write_b128 v4, v[48:51] offset:256
    ds_write_b128 v4, v[52:55] offset:272
    v_and_b32 v5, 127, v0
    v_lshrrev_b32 v6, 7, v0
    v_mul_u32_u24 v7, 8448, v6
    v_lshl_add_u32 v7, v5, 2, v7
    s_waitcnt lgkmcnt(0)
    s_barrier
    ds_read_b32 v8, v7 offset:0
    ds_read_b32 v9, v7 offset:528
    ds_read_b32 v10, v7 offset:1056
    ds_read_b32 v11, v7 offset:1584
    ds_read_b32 v12, v7 offset:2112
    ds_read_b32 v13, v7 offset:2640
    ds_read_b32 v14, v7 offset:3168
    ds_read_b32 v15, v7 offset:3696
    ds_read_b32 v16, v7 offset:4224
    ds_read_b32 v17, v7 offset:4752
    ds_read_b32 v18, v7 offset:5280
    ds_read_b32 v19, v7 offset:5808
    ds_read_b32 v20, v7 offset:6336
    ds_read_b32 v21, v7 offset:6864
    ds_read_b32 v22, v7 offset:7392
    ds_read_b32 v23, v7 offset:7920
    s_waitcnt lgkmcnt(0)
    v_add_f32 v8, v8, v16
    v_add_f32 v9, v9, v17
    v_add_f32 v10, v10, v18
    v_add_f32 v11, v11, v19
    v_add_f32 v12, v12, v20
    v_add_f32 v13, v13, v21
    v_add_f32 v14, v14, v22
    v_add_f32 v15, v15, v23
    v_add_f32 v8, v8, v12
    v_add_f32 v9, v9, v13
    v_add_f32 v10, v10, v14
    v_add_f32 v11, v11, v15
    v_add_f32 v8, v8, v10
    v_add_f32 v9, v9, v11
    v_add_f32 v8, v8, v9
    v_lshlrev_b32 v7, 2, v0
    ds_write_b32 v7, v8 offset:33792
    s_waitcnt lgkmcnt(0)
    s_barrier
    s_cmp_lg_u32 s22, 0
    s_cbranch_scc1 AUX_done
    ds_read_b32 v8, v7 offset:33792
    ds_read_b32 v12, v7 offset:34048
    ds_read_b32 v9, v7 offset:34304
    ds_read_b32 v13, v7 offset:34560
    ds_read_b32 v10, v7 offset:34816
    ds_read_b32 v14, v7 offset:35072
    ds_read_b32 v11, v7 offset:35328
    ds_read_b32 v15, v7 offset:35584
    s_lshl_b32 s26, s2, 8
    s_add_u32 s27, s26, 0x30000
    s_add_u32 s26, s26, 0x20000
    s_waitcnt lgkmcnt(0)
    v_add_f32 v8, v8, v9
    v_add_f32 v10, v10, v11
    v_add_f32 v12, v12, v13
    v_add_f32 v14, v14, v15
    v_add_f32 v40, v8, v10
    v_add_f32 v41, v12, v14
    v_mul_f32 v40, 0x3b124925, v40
    v_cvt_pk_bf16_f32 v42, v40, v40
    v_lshlrev_b32 v42, 16, v42
    buffer_store_dword v42, v7, s[60:63], s27 offen sc1
    v_mul_f32 v41, 0x3b124925, v41
    v_fma_f32 v41, -v40, v40, v41
    v_max_f32 v41, 0, v41
    v_cvt_pk_bf16_f32 v41, v41, v41
    v_lshlrev_b32 v41, 16, v41
    v_add_f32 v41, 0x3727c5ac, v41
    v_cvt_pk_bf16_f32 v41, v41, v41
    v_lshlrev_b32 v41, 16, v41
    v_sqrt_f32 v41, v41
    s_nop 0
    v_cvt_pk_bf16_f32 v41, v41, v41
    v_lshlrev_b32 v41, 16, v41
    v_mul_f32 v41, v41, v41
    v_rcp_f32 v41, v41
    v_and_b32 v2, 63, v0
    buffer_store_dword v41, v7, s[60:63], s26 offen sc1
    s_waitcnt vmcnt(0)
    s_lshr_b32 s28, s2, 2
    s_lshl_b32 s28, s28, 7
    s_and_b32 s32, s2, 3
    s_lshl_b32 s32, s32, 2
    s_add_u32 s28, s28, s32
    s_add_u32 s28, s28, 0x60000
    v_mul_u32_u24 v1, 8320, v2
    v_mov_b32 v3, s42
    s_mov_b64 exec, 15
    buffer_store_dword v3, v1, s[60:63], s28 offen sc1
    s_mov_b64 exec, -1
AUX_done:
    s_endpgm
EXIT:
    s_endpgm
CODE_END:
.p2align 6
.type KG_TABLE,@object
KG_TABLE:
.long 17920, 17920, 17920, 17920
.long 17916, 17916, 17916, 17912
.long 17912, 17912, 17912, 17912
.long 17908, 17908, 17908, 17904
.long 17904, 17904, 17904, 17904
.long 17900, 17900, 17900, 17896
.long 17896, 17896, 17896, 17896
.long 17892, 17892, 17892, 17888
.long 17888, 17888, 17888, 17888
.long 17884, 17884, 17884, 17880
.long 17880, 17880, 17880, 17880
.long 17876, 17876, 17876, 17872
.long 17872, 17872, 17872, 17872
.long 17868, 17868, 17868, 17864
.long 17864, 17864, 17864, 17864
.long 17860, 17860, 17860, 17856
.long 17856, 17856, 17856, 17856
.long 17852, 17852, 17852, 17848
.long 17848, 17848, 17848, 17848
.long 17844, 17844, 17844, 17840
.long 17840, 17840, 17840, 17840
.long 17836, 17836, 17836, 17832
.long 17832, 17832, 17832, 17832
.long 17828, 17828, 17828, 17824
.long 17824, 17824, 17824, 17824
.long 17820, 17820, 17820, 17816
.long 17816, 17816, 17816, 17816
.long 17812, 17812, 17812, 17808
.long 17808, 17808, 17808, 17808
.long 17804, 17804, 17804, 17800
.long 17800, 17800, 17800, 17800
.long 17796, 17796, 17796, 17792
.long 17792, 17792, 17792, 17792
.long 17788, 17788, 17788, 17784
.long 17784, 17784, 17784, 17784
.long 17780, 17780, 17780, 17776
.long 17776, 17776, 17776, 17776
.long 17772, 17772, 17772, 17768
.long 17768, 17768, 17768, 17768
.long 17764, 17764, 17764, 17760
.long 17760, 17760, 17760, 17760
.long 17756, 17756, 17756, 17752
.long 17752, 17752, 17752, 17752
.long 17748, 17748, 17748, 17744
.long 17744, 17744, 17744, 17744
.long 17740, 17740, 17740, 17736
.long 17736, 17736, 17736, 17736
.long 17732, 17732, 17732, 17728
.long 17728, 17728, 17728, 17728
.long 17724, 17724, 17724, 17720
.long 17720, 17720, 17720, 17720
.long 17716, 17716, 17716, 17712
.long 17712, 17712, 17712, 17712
.long 17708, 17708, 17708, 17704
.long 17704, 17704, 17704, 17704
.long 17700, 17700, 17700, 17696
.long 17696, 17696, 17696, 17696
.long 17692, 17692, 17692, 17688
.long 17688, 17688, 17688, 17688
.long 17684, 17684, 17684, 17680
.long 17680, 17680, 17680, 17680
.long 17676, 17676, 17676, 17672
.long 17672, 17672, 17672, 17672
.long 17668, 17668, 17668, 17664
.long 17664, 17664, 17664, 17664
.long 17660, 17660, 17660, 17656
.long 17656, 17656, 17656, 17656
.long 17652, 17652, 17652, 17648
.long 17648, 17648, 17648, 17648
.long 17644, 17644, 17644, 17640
.long 17640, 17640, 17640, 17640
.long 17636, 17636, 17636, 17632
.long 17632, 17632, 17632, 17632
.long 17628, 17628, 17628, 17624
.long 17624, 17624, 17624, 17624
.long 17620, 17620, 17620, 17616
.long 17616, 17616, 17616, 17616
.long 17612, 17612, 17612, 17608
.long 17608, 17608, 17608, 17608
.long 17604, 17604, 17604, 17600
.long 17600, 17600, 17600, 17600
.long 17596, 17596, 17596, 17592
.long 17592, 17592, 17592, 17592
.long 17588, 17588, 17588, 17584
.long 17584, 17584, 17584, 17584
.long 17580, 17580, 17580, 17576
.long 17576, 17576, 17576, 17576
.long 17572, 17572, 17572, 17568
.long 17568, 17568, 17568, 17568
.long 17564, 17564, 17564, 17560
.long 17560, 17560, 17560, 17560
.long 17556, 17556, 17556, 17552
.long 17552, 17552, 17552, 17552
.long 17548, 17548, 17548, 17544
.long 17544, 17544, 17544, 17544
.long 17540, 17540, 17540, 17536
.long 17536, 17536, 17536, 17536
.long 17532, 17532, 17532, 17528
.long 17528, 17528, 17528, 17528
.long 17524, 17524, 17524, 17520
.long 17520, 17520, 17520, 17520
.long 17516, 17516, 17516, 17512
.long 17512, 17512, 17512, 17512
.long 17508, 17508, 17508, 17504
.long 17504, 17504, 17504, 17504
.long 17500, 17500, 17500, 17496
.long 17496, 17496, 17496, 17496
.long 17492, 17492, 17492, 17488
.long 17488, 17488, 17488, 17488
.long 17484, 17484, 17484, 17480
.long 17480, 17480, 17480, 17480
.long 17476, 17476, 17476, 17472
.long 17472, 17472, 17472, 17472
.long 17468, 17468, 17468, 17464
.long 17464, 17464, 17464, 17464
.long 17460, 17460, 17460, 17456
.long 17456, 17456, 17456, 17456
.long 17452, 17452, 17452, 17448
.long 17448, 17448, 17448, 17448
.long 17444, 17444, 17444, 17440
.long 17440, 17440, 17440, 17440
.long 17436, 17436, 17436, 17432
.long 17432, 17432, 17432, 17432
.long 17428, 17428, 17428, 17424
.long 17424, 17424, 17424, 17424
.long 17420, 17420, 17420, 17416
.long 17416, 17416, 17416, 17416
.long 17412, 17412, 17412, 17408
.long 17408, 17408, 21756, 21756
.long 17404, 17404, 21752, 21752
.long 17400, 17400, 21748, 21748
.long 17396, 17396, 21744, 21744
.long 17392, 17392, 21740, 21740
.long 17388, 17388, 21736, 21736
.long 17384, 17384, 21732, 21732
.long 17380, 17380, 21728, 21728
.long 17376, 17376, 21724, 21724
.long 17372, 17372, 21720, 21720
.long 17368, 17368, 21716, 21716
.long 17364, 17364, 21712, 21712
.long 17360, 17360, 21708, 21708
.long 17356, 17356, 21704, 21704
.long 17352, 17352, 21700, 21700
.long 17348, 17348, 21696, 21696
.long 17344, 17344, 21692, 21692
.long 17340, 17340, 21688, 21688
.long 17336, 17336, 21684, 21684
.long 17332, 17332, 21680, 21680
.long 17328, 17328, 21676, 21676
.long 17324, 17324, 21672, 21672
.long 17320, 17320, 21668, 21668
.long 17316, 17316, 21664, 21664
.long 17312, 17312, 21660, 21660
.long 17308, 17308, 21656, 21656
.long 17304, 17304, 21652, 21652
.long 17300, 17300, 21648, 21648
.long 17296, 17296, 21644, 21644
.long 17292, 17292, 21640, 21640
.long 17288, 17288, 21636, 21636
.long 17284, 17284, 21632, 21632
.long 17280, 17280, 21628, 21628
.long 17276, 17276, 21624, 21624
.long 17272, 17272, 21620, 21620
.long 17268, 17268, 21616, 21616
.long 17264, 17264, 21612, 21612
.long 17260, 17260, 21608, 21608
.long 17256, 17256, 21604, 21604
.long 17252, 17252, 21600, 21600
.long 17248, 17248, 21596, 21596
.long 17244, 17244, 21592, 21592
.long 17240, 17240, 21588, 21588
.long 17236, 17236, 21584, 21584
.long 17232, 17232, 21580, 21580
.long 17228, 17228, 21576, 21576
.long 17224, 17224, 21572, 21572
.long 17220, 17220, 21568, 21568
.long 17216, 17216, 21564, 21564
.long 17212, 17212, 21560, 21560
.long 17208, 17208, 21556, 21556
.long 17204, 17204, 21552, 21552
.long 17200, 17200, 21548, 21548
.long 17196, 17196, 21544, 21544
.long 17192, 17192, 21540, 21540
.long 17188, 17188, 21536, 21536
.long 17184, 17184, 21532, 21532
.long 17180, 17180, 21528, 21528
.long 17176, 17176, 21524, 21524
.long 17172, 17172, 21520, 21520
.long 17168, 17168, 21516, 21516
.long 17164, 17164, 21512, 21512
.long 17160, 17160, 21508, 21508
.long 17156, 17156, 21504, 21504
.long 17152, 23676, 21500, 21500
.long 17148, 23672, 21496, 21496
.long 17144, 23668, 21492, 21492
.long 17140, 23664, 21488, 21488
.long 17136, 23660, 21484, 21484
.long 17132, 23656, 21480, 21480
.long 17128, 23652, 21476, 21476
.long 17124, 23648, 21472, 21472
.long 17120, 23644, 21468, 21468
.long 17116, 23640, 21464, 21464
.long 17112, 23636, 21460, 21460
.long 17108, 23632, 21456, 21456
.long 17104, 23628, 21452, 21452
.long 17100, 23624, 21448, 21448
.long 17096, 23620, 21444, 21444
.long 17092, 23616, 21440, 21440
.long 17088, 23612, 21436, 21436
.long 17084, 23608, 21432, 21432
.long 17080, 23604, 21428, 21428
.long 17076, 23600, 21424, 21424
.long 17072, 23596, 21420, 21420
.long 17068, 23592, 21416, 21416
.long 17064, 23588, 21412, 21412
.long 17060, 23584, 21408, 21408
.long 17056, 23580, 21404, 21404
.long 17052, 23576, 21400, 21400
.long 17048, 23572, 21396, 21396
.long 17044, 23568, 21392, 21392
.long 17040, 23564, 21388, 21388
.long 17036, 23560, 21384, 21384
.long 17032, 23556, 21380, 21380
.long 17028, 23552, 21376, 21376
.long 24636, 23548, 22460, 21372
.long 24632, 23544, 22456, 21368
.long 24628, 23540, 22452, 21364
.long 24624, 23536, 22448, 21360
.long 24620, 23532, 22444, 21356
.long 24616, 23528, 22440, 21352
.long 24612, 23524, 22436, 21348
.long 24608, 23520, 22432, 21344
.long 24604, 23516, 22428, 21340
.long 24600, 23512, 22424, 21336
.long 24596, 23508, 22420, 21332
.long 24592, 23504, 22416, 21328
.long 24588, 23500, 22412, 21324
.long 24584, 23496, 22408, 21320
.long 24580, 23492, 22404, 21316
.long 24576, 23488, 22400, 21312
.long 24572, 23484, 22396, 21308
.long 24568, 23480, 22392, 21304
.long 24564, 23476, 22388, 21300
.long 24560, 23472, 22384, 21296
.long 24556, 23468, 22380, 21292
.long 24552, 23464, 22376, 21288
.long 24548, 23460, 22372, 21284
.long 24544, 23456, 22368, 21280
.long 24540, 23452, 22364, 21276
.long 24536, 23448, 22360, 21272
.long 24532, 23444, 22356, 21268
.long 24528, 23440, 22352, 21264
.long 24524, 23436, 22348, 21260
.long 24520, 23432, 22344, 21256
.long 24516, 23428, 22340, 21252
.long 24512, 23424, 22336, 21248
.long 26624, 26624, 26624, 26624
.long 26620, 26620, 26620, 26616
.long 26616, 26616, 26616, 26616
.long 26612, 26612, 26612, 26608
.long 26608, 26608, 26608, 26608
.long 26604, 26604, 26604, 26600
.long 26600, 26600, 26600, 26600
.long 26596, 26596, 26596, 26592
.long 26592, 26592, 26592, 26592
.long 26588, 26588, 26588, 26584
.long 26584, 26584, 26584, 26584
.long 26580, 26580, 26580, 26576
.long 26576, 26576, 26576, 26576
.long 26572, 26572, 26572, 26568
.long 26568, 26568, 26568, 26568
.long 26564, 26564, 26564, 26560
.long 26560, 26560, 26560, 26560
.long 26556, 26556, 26556, 26552
.long 26552, 26552, 26552, 26552
.long 26548, 26548, 26548, 26544
.long 26544, 26544, 26544, 26544
.long 26540, 26540, 26540, 26536
.long 26536, 26536, 26536, 26536
.long 26532, 26532, 26532, 26528
.long 26528, 26528, 26528, 26528
.long 26524, 26524, 26524, 26520
.long 26520, 26520, 26520, 26520
.long 26516, 26516, 26516, 26512
.long 26512, 26512, 26512, 26512
.long 26508, 26508, 26508, 26504
.long 26504, 26504, 26504, 26504
.long 26500, 26500, 26500, 26496
.long 26496, 26496, 26496, 26496
.long 26492, 26492, 26492, 26488
.long 26488, 26488, 26488, 26488
.long 26484, 26484, 26484, 26480
.long 26480, 26480, 26480, 26480
.long 26476, 26476, 26476, 26472
.long 26472, 26472, 26472, 26472
.long 26468, 26468, 26468, 26464
.long 26464, 26464, 26464, 26464
.long 26460, 26460, 26460, 26456
.long 26456, 26456, 26456, 26456
.long 26452, 26452, 26452, 26448
.long 26448, 26448, 26448, 26448
.long 26444, 26444, 26444, 26440
.long 26440, 26440, 26440, 26440
.long 26436, 26436, 26436, 26432
.long 26432, 26432, 26432, 26432
.long 26428, 26428, 26428, 26424
.long 26424, 26424, 26424, 26424
.long 26420, 26420, 26420, 26416
.long 26416, 26416, 26416, 26416
.long 26412, 26412, 26412, 26408
.long 26408, 26408, 26408, 26408
.long 26404, 26404, 26404, 26400
.long 26400, 26400, 26400, 26400
.long 26396, 26396, 26396, 26392
.long 26392, 26392, 26392, 26392
.long 26388, 26388, 26388, 26384
.long 26384, 26384, 26384, 26384
.long 26380, 26380, 26380, 26376
.long 26376, 26376, 26376, 26376
.long 26372, 26372, 26372, 26368
.long 26368, 26368, 26368, 26368
.long 26364, 26364, 26364, 26360
.long 26360, 26360, 26360, 26360
.long 26356, 26356, 26356, 26352
.long 26352, 26352, 26352, 26352
.long 26348, 26348, 26348, 26344
.long 26344, 26344, 26344, 26344
.long 26340, 26340, 26340, 26336
.long 26336, 26336, 26336, 26336
.long 26332, 26332, 26332, 26328
.long 26328, 26328, 26328, 26328
.long 26324, 26324, 26324, 26320
.long 26320, 26320, 26320, 26320
.long 26316, 26316, 26316, 26312
.long 26312, 26312, 26312, 26312
.long 26308, 26308, 26308, 26304
.long 26304, 26304, 26304, 26304
.long 26300, 26300, 26300, 26296
.long 26296, 26296, 26296, 26296
.long 26292, 26292, 26292, 26288
.long 26288, 26288, 26288, 26288
.long 26284, 26284, 26284, 26280
.long 26280, 26280, 26280, 26280
.long 26276, 26276, 26276, 26272
.long 26272, 26272, 26272, 26272
.long 26268, 26268, 26268, 26264
.long 26264, 26264, 26264, 26264
.long 26260, 26260, 26260, 26256
.long 26256, 26256, 26256, 26256
.long 26252, 26252, 26252, 26248
.long 26248, 26248, 26248, 26248
.long 26244, 26244, 26244, 26240
.long 26240, 26240, 26240, 26240
.long 26236, 26236, 26236, 26232
.long 26232, 26232, 26232, 26232
.long 26228, 26228, 26228, 26224
.long 26224, 26224, 26224, 26224
.long 26220, 26220, 26220, 26216
.long 26216, 26216, 26216, 26216
.long 26212, 26212, 26212, 26208
.long 26208, 26208, 26208, 26208
.long 26204, 26204, 26204, 26200
.long 26200, 26200, 26200, 26200
.long 26196, 26196, 26196, 26192
.long 26192, 26192, 26192, 26192
.long 26188, 26188, 26188, 26184
.long 26184, 26184, 26184, 26184
.long 26180, 26180, 26180, 26176
.long 26176, 26176, 26176, 26176
.long 26172, 26172, 26172, 26168
.long 26168, 26168, 26168, 26168
.long 26164, 26164, 26164, 26160
.long 26160, 26160, 26160, 26160
.long 26156, 26156, 26156, 26152
.long 26152, 26152, 26152, 26152
.long 26148, 26148, 26148, 26144
.long 26144, 26144, 26144, 26144
.long 26140, 26140, 26140, 26136
.long 26136, 26136, 26136, 26136
.long 26132, 26132, 26132, 26128
.long 26128, 26128, 26128, 26128
.long 26124, 26124, 26124, 26120
.long 26120, 26120, 26120, 26120
.long 26116, 26116, 26116, 26112
.long 26112, 26112, 30460, 30460
.long 26108, 26108, 30456, 30456
.long 26104, 26104, 30452, 30452
.long 26100, 26100, 30448, 30448
.long 26096, 26096, 30444, 30444
.long 26092, 26092, 30440, 30440
.long 26088, 26088, 30436, 30436
.long 26084, 26084, 30432, 30432
.long 26080, 26080, 30428, 30428
.long 26076, 26076, 30424, 30424
.long 26072, 26072, 30420, 30420
.long 26068, 26068, 30416, 30416
.long 26064, 26064, 30412, 30412
.long 26060, 26060, 30408, 30408
.long 26056, 26056, 30404, 30404
.long 26052, 26052, 30400, 30400
.long 26048, 26048, 30396, 30396
.long 26044, 26044, 30392, 30392
.long 26040, 26040, 30388, 30388
.long 26036, 26036, 30384, 30384
.long 26032, 26032, 30380, 30380
.long 26028, 26028, 30376, 30376
.long 26024, 26024, 30372, 30372
.long 26020, 26020, 30368, 30368
.long 26016, 26016, 30364, 30364
.long 26012, 26012, 30360, 30360
.long 26008, 26008, 30356, 30356
.long 26004, 26004, 30352, 30352
.long 26000, 26000, 30348, 30348
.long 25996, 25996, 30344, 30344
.long 25992, 25992, 30340, 30340
.long 25988, 25988, 30336, 30336
.long 25984, 25984, 30332, 30332
.long 25980, 25980, 30328, 30328
.long 25976, 25976, 30324, 30324
.long 25972, 25972, 30320, 30320
.long 25968, 25968, 30316, 30316
.long 25964, 25964, 30312, 30312
.long 25960, 25960, 30308, 30308
.long 25956, 25956, 30304, 30304
.long 25952, 25952, 30300, 30300
.long 25948, 25948, 30296, 30296
.long 25944, 25944, 30292, 30292
.long 25940, 25940, 30288, 30288
.long 25936, 25936, 30284, 30284
.long 25932, 25932, 30280, 30280
.long 25928, 25928, 30276, 30276
.long 25924, 25924, 30272, 30272
.long 25920, 25920, 30268, 30268
.long 25916, 25916, 30264, 30264
.long 25912, 25912, 30260, 30260
.long 25908, 25908, 30256, 30256
.long 25904, 25904, 30252, 30252
.long 25900, 25900, 30248, 30248
.long 25896, 25896, 30244, 30244
.long 25892, 25892, 30240, 30240
.long 25888, 25888, 30236, 30236
.long 25884, 25884, 30232, 30232
.long 25880, 25880, 30228, 30228
.long 25876, 25876, 30224, 30224
.long 25872, 25872, 30220, 30220
.long 25868, 25868, 30216, 30216
.long 25864, 25864, 30212, 30212
.long 25860, 25860, 30208, 30208
.long 25856, 32380, 30204, 30204
.long 25852, 32376, 30200, 30200
.long 25848, 32372, 30196, 30196
.long 25844, 32368, 30192, 30192
.long 25840, 32364, 30188, 30188
.long 25836, 32360, 30184, 30184
.long 25832, 32356, 30180, 30180
.long 25828, 32352, 30176, 30176
.long 25824, 32348, 30172, 30172
.long 25820, 32344, 30168, 30168
.long 25816, 32340, 30164, 30164
.long 25812, 32336, 30160, 30160
.long 25808, 32332, 30156, 30156
.long 25804, 32328, 30152, 30152
.long 25800, 32324, 30148, 30148
.long 25796, 32320, 30144, 30144
.long 25792, 32316, 30140, 30140
.long 25788, 32312, 30136, 30136
.long 25784, 32308, 30132, 30132
.long 25780, 32304, 30128, 30128
.long 25776, 32300, 30124, 30124
.long 25772, 32296, 30120, 30120
.long 25768, 32292, 30116, 30116
.long 25764, 32288, 30112, 30112
.long 25760, 32284, 30108, 30108
.long 25756, 32280, 30104, 30104
.long 25752, 32276, 30100, 30100
.long 25748, 32272, 30096, 30096
.long 25744, 32268, 30092, 30092
.long 25740, 32264, 30088, 30088
.long 25736, 32260, 30084, 30084
.long 25732, 32256, 30080, 30080
.long 33340, 32252, 31164, 30076
.long 33336, 32248, 31160, 30072
.long 33332, 32244, 31156, 30068
.long 33328, 32240, 31152, 30064
.long 33324, 32236, 31148, 30060
.long 33320, 32232, 31144, 30056
.long 33316, 32228, 31140, 30052
.long 33312, 32224, 31136, 30048
.long 33308, 32220, 31132, 30044
.long 33304, 32216, 31128, 30040
.long 33300, 32212, 31124, 30036
.long 33296, 32208, 31120, 30032
.long 33292, 32204, 31116, 30028
.long 33288, 32200, 31112, 30024
.long 33284, 32196, 31108, 30020
.long 33280, 32192, 31104, 30016
.long 33276, 32188, 31100, 30012
.long 33272, 32184, 31096, 30008
.long 33268, 32180, 31092, 30004
.long 33264, 32176, 31088, 30000
.long 33260, 32172, 31084, 29996
.long 33256, 32168, 31080, 29992
.long 33252, 32164, 31076, 29988
.long 33248, 32160, 31072, 29984
.long 33244, 32156, 31068, 29980
.long 33240, 32152, 31064, 29976
.long 33236, 32148, 31060, 29972
.long 33232, 32144, 31056, 29968
.long 33228, 32140, 31052, 29964
.long 33224, 32136, 31048, 29960
.long 33220, 32132, 31044, 29956
.long 33216, 32128, 31040, 29952
.long 17916, 17916, 17916, 17916
.long 17912, 17912, 17912, 17912
.long 17908, 17908, 17908, 17908
.long 17904, 17904, 17904, 17904
.long 17900, 17900, 17900, 17900
.long 17896, 17896, 17896, 17896
.long 17892, 17892, 17892, 17892
.long 17888, 17888, 17888, 17888
.long 17884, 17884, 17884, 17884
.long 17880, 17880, 17880, 17880
.long 17876, 17876, 17876, 17876
.long 17872, 17872, 17872, 17872
.long 17868, 17868, 17868, 17868
.long 17864, 17864, 17864, 17864
.long 17860, 17860, 17860, 17860
.long 17856, 17856, 17856, 17856
.long 17852, 17852, 17852, 17852
.long 17848, 17848, 17848, 17848
.long 17844, 17844, 17844, 17844
.long 17840, 17840, 17840, 17840
.long 17836, 17836, 17836, 17836
.long 17832, 17832, 17832, 17832
.long 17828, 17828, 17828, 17828
.long 17824, 17824, 17824, 17824
.long 17820, 17820, 17820, 17820
.long 17816, 17816, 17816, 17816
.long 17812, 17812, 17812, 17812
.long 17808, 17808, 17808, 17808
.long 17804, 17804, 17804, 17804
.long 17800, 17800, 17800, 17800
.long 17796, 17796, 17796, 17796
.long 17792, 17792, 17792, 17792
.long 17788, 17788, 17788, 17788
.long 17784, 17784, 17784, 17784
.long 17780, 17780, 17780, 17780
.long 17776, 17776, 17776, 17776
.long 17772, 17772, 17772, 17772
.long 17768, 17768, 17768, 17768
.long 17764, 17764, 17764, 17764
.long 17760, 17760, 17760, 17760
.long 17756, 17756, 17756, 17756
.long 17752, 17752, 17752, 17752
.long 17748, 17748, 17748, 17748
.long 17744, 17744, 17744, 17744
.long 17740, 17740, 17740, 17740
.long 17736, 17736, 17736, 17736
.long 17732, 17732, 17732, 17732
.long 17728, 17728, 17728, 17728
.long 17724, 17724, 17724, 17724
.long 17720, 17720, 17720, 17720
.long 17716, 17716, 17716, 17716
.long 17712, 17712, 17712, 17712
.long 17708, 17708, 17708, 17708
.long 17704, 17704, 17704, 17704
.long 17700, 17700, 17700, 17700
.long 17696, 17696, 17696, 17696
.long 17692, 17692, 17692, 17692
.long 17688, 17688, 17688, 17688
.long 17684, 17684, 17684, 17684
.long 17680, 17680, 17680, 17680
.long 17676, 17676, 17676, 17676
.long 17672, 17672, 17672, 17672
.long 17668, 17668, 17668, 17668
.long 17664, 17664, 17664, 17664
.long 17660, 17660, 17660, 17660
.long 17656, 17656, 17656, 17656
.long 17652, 17652, 17652, 17652
.long 17648, 17648, 17648, 17648
.long 17644, 17644, 17644, 17644
.long 17640, 17640, 17640, 17640
.long 17636, 17636, 17636, 17636
.long 17632, 17632, 17632, 17632
.long 17628, 17628, 17628, 17628
.long 17624, 17624, 17624, 17624
.long 17620, 17620, 17620, 17620
.long 17616, 17616, 17616, 17616
.long 17612, 17612, 17612, 17612
.long 17608, 17608, 17608, 17608
.long 17604, 17604, 17604, 17604
.long 17600, 17600, 17600, 17600
.long 17596, 17596, 17596, 17596
.long 17592, 17592, 17592, 17592
.long 17588, 17588, 17588, 17588
.long 17584, 17584, 17584, 17584
.long 17580, 17580, 17580, 17580
.long 17576, 17576, 17576, 17576
.long 17572, 17572, 17572, 17572
.long 17568, 17568, 17568, 17568
.long 17564, 17564, 17564, 17564
.long 17560, 17560, 17560, 17560
.long 17556, 17556, 17556, 17556
.long 17552, 17552, 17552, 17552
.long 17548, 17548, 17548, 17548
.long 17544, 17544, 17544, 17544
.long 17540, 17540, 17540, 17540
.long 17536, 17536, 17536, 17536
.long 17532, 17532, 17532, 17532
.long 17528, 17528, 17528, 17528
.long 17524, 17524, 17524, 17524
.long 17520, 17520, 17520, 17520
.long 17516, 17516, 17516, 17516
.long 17512, 17512, 17512, 17512
.long 17508, 17508, 17508, 17508
.long 17504, 17504, 17504, 17504
.long 17500, 17500, 17500, 17500
.long 17496, 17496, 17496, 17496
.long 17492, 17492, 17492, 17492
.long 17488, 17488, 17488, 17488
.long 17484, 17484, 17484, 17484
.long 17480, 17480, 17480, 17480
.long 17476, 17476, 17476, 17476
.long 17472, 17472, 17472, 17472
.long 17468, 17468, 17468, 17468
.long 17464, 17464, 17464, 17464
.long 17460, 17460, 17460, 17460
.long 17456, 17456, 17456, 17456
.long 17452, 17452, 17452, 17452
.long 17448, 17448, 17448, 17448
.long 17444, 17444, 17444, 17444
.long 17440, 17440, 17440, 17440
.long 17436, 17436, 17436, 17436
.long 17432, 17432, 17432, 17432
.long 17428, 17428, 17428, 17428
.long 17424, 17424, 17424, 17424
.long 17420, 17420, 17420, 17420
.long 17416, 17416, 17416, 17416
.long 17412, 17412, 17412, 17412
.long 17408, 17408, 17408, 17408
.long 21756, 17404, 17404, 17404
.long 21752, 17400, 17400, 17400
.long 21748, 17396, 17396, 17396
.long 21744, 17392, 17392, 17392
.long 21740, 17388, 17388, 17388
.long 21736, 17384, 17384, 17384
.long 21732, 17380, 17380, 17380
.long 21728, 17376, 17376, 17376
.long 21724, 17372, 17372, 17372
.long 21720, 17368, 17368, 17368
.long 21716, 17364, 17364, 17364
.long 21712, 17360, 17360, 17360
.long 21708, 17356, 17356, 17356
.long 21704, 17352, 17352, 17352
.long 21700, 17348, 17348, 17348
.long 21696, 17344, 17344, 17344
.long 21692, 17340, 17340, 17340
.long 21688, 17336, 17336, 17336
.long 21684, 17332, 17332, 17332
.long 21680, 17328, 17328, 17328
.long 21676, 17324, 17324, 17324
.long 21672, 17320, 17320, 17320
.long 21668, 17316, 17316, 17316
.long 21664, 17312, 17312, 17312
.long 21660, 17308, 17308, 17308
.long 21656, 17304, 17304, 17304
.long 21652, 17300, 17300, 17300
.long 21648, 17296, 17296, 17296
.long 21644, 17292, 17292, 17292
.long 21640, 17288, 17288, 17288
.long 21636, 17284, 17284, 17284
.long 21632, 17280, 17280, 17280
.long 21628, 17276, 17276, 17276
.long 21624, 17272, 17272, 17272
.long 21620, 17268, 17268, 17268
.long 21616, 17264, 17264, 17264
.long 21612, 17260, 17260, 17260
.long 21608, 17256, 17256, 17256
.long 21604, 17252, 17252, 17252
.long 21600, 17248, 17248, 17248
.long 21596, 17244, 17244, 17244
.long 21592, 17240, 17240, 17240
.long 21588, 17236, 17236, 17236
.long 21584, 17232, 17232, 17232
.long 21580, 17228, 17228, 17228
.long 21576, 17224, 17224, 17224
.long 21572, 17220, 17220, 17220
.long 21568, 17216, 17216, 17216
.long 21564, 17212, 17212, 17212
.long 21560, 17208, 17208, 17208
.long 21556, 17204, 17204, 17204
.long 21552, 17200, 17200, 17200
.long 21548, 17196, 17196, 17196
.long 21544, 17192, 17192, 17192
.long 21540, 17188, 17188, 17188
.long 21536, 17184, 17184, 17184
.long 21532, 17180, 17180, 17180
.long 21528, 17176, 17176, 17176
.long 21524, 17172, 17172, 17172
.long 21520, 17168, 17168, 17168
.long 21516, 17164, 17164, 17164
.long 21512, 17160, 17160, 17160
.long 21508, 17156, 17156, 17156
.long 21504, 17152, 17152, 17152
.long 21500, 19324, 17148, 17148
.long 21496, 19320, 17144, 17144
.long 21492, 19316, 17140, 17140
.long 21488, 19312, 17136, 17136
.long 21484, 19308, 17132, 17132
.long 21480, 19304, 17128, 17128
.long 21476, 19300, 17124, 17124
.long 21472, 19296, 17120, 17120
.long 21468, 19292, 17116, 17116
.long 21464, 19288, 17112, 17112
.long 21460, 19284, 17108, 17108
.long 21456, 19280, 17104, 17104
.long 21452, 19276, 17100, 17100
.long 21448, 19272, 17096, 17096
.long 21444, 19268, 17092, 17092
.long 21440, 19264, 17088, 17088
.long 21436, 19260, 17084, 17084
.long 21432, 19256, 17080, 17080
.long 21428, 19252, 17076, 17076
.long 21424, 19248, 17072, 17072
.long 21420, 19244, 17068, 17068
.long 21416, 19240, 17064, 17064
.long 21412, 19236, 17060, 17060
.long 21408, 19232, 17056, 17056
.long 21404, 19228, 17052, 17052
.long 21400, 19224, 17048, 17048
.long 21396, 19220, 17044, 17044
.long 21392, 19216, 17040, 17040
.long 21388, 19212, 17036, 17036
.long 21384, 19208, 17032, 17032
.long 21380, 19204, 17028, 17028
.long 21376, 19200, 17024, 17024
.long 20284, 19196, 18108, 17020
.long 20280, 19192, 18104, 17016
.long 20276, 19188, 18100, 17012
.long 20272, 19184, 18096, 17008
.long 20268, 19180, 18092, 17004
.long 20264, 19176, 18088, 17000
.long 20260, 19172, 18084, 16996
.long 20256, 19168, 18080, 16992
.long 20252, 19164, 18076, 16988
.long 20248, 19160, 18072, 16984
.long 20244, 19156, 18068, 16980
.long 20240, 19152, 18064, 16976
.long 20236, 19148, 18060, 16972
.long 20232, 19144, 18056, 16968
.long 20228, 19140, 18052, 16964
.long 20224, 19136, 18048, 16960
.long 20220, 19132, 18044, 16956
.long 20216, 19128, 18040, 16952
.long 20212, 19124, 18036, 16948
.long 20208, 19120, 18032, 16944
.long 20204, 19116, 18028, 16940
.long 20200, 19112, 18024, 16936
.long 20196, 19108, 18020, 16932
.long 20192, 19104, 18016, 16928
.long 20188, 19100, 18012, 16924
.long 20184, 19096, 18008, 16920
.long 20180, 19092, 18004, 16916
.long 20176, 19088, 18000, 16912
.long 20172, 19084, 17996, 16908
.long 20168, 19080, 17992, 16904
.long 20164, 19076, 17988, 16900
.long 20160, 19072, 17984, 16896
.long 26620, 26620, 26620, 26620
.long 26616, 26616, 26616, 26616
.long 26612, 26612, 26612, 26612
.long 26608, 26608, 26608, 26608
.long 26604, 26604, 26604, 26604
.long 26600, 26600, 26600, 26600
.long 26596, 26596, 26596, 26596
.long 26592, 26592, 26592, 26592
.long 26588, 26588, 26588, 26588
.long 26584, 26584, 26584, 26584
.long 26580, 26580, 26580, 26580
.long 26576, 26576, 26576, 26576
.long 26572, 26572, 26572, 26572
.long 26568, 26568, 26568, 26568
.long 26564, 26564, 26564, 26564
.long 26560, 26560, 26560, 26560
.long 26556, 26556, 26556, 26556
.long 26552, 26552, 26552, 26552
.long 26548, 26548, 26548, 26548
.long 26544, 26544, 26544, 26544
.long 26540, 26540, 26540, 26540
.long 26536, 26536, 26536, 26536
.long 26532, 26532, 26532, 26532
.long 26528, 26528, 26528, 26528
.long 26524, 26524, 26524, 26524
.long 26520, 26520, 26520, 26520
.long 26516, 26516, 26516, 26516
.long 26512, 26512, 26512, 26512
.long 26508, 26508, 26508, 26508
.long 26504, 26504, 26504, 26504
.long 26500, 26500, 26500, 26500
.long 26496, 26496, 26496, 26496
.long 26492, 26492, 26492, 26492
.long 26488, 26488, 26488, 26488
.long 26484, 26484, 26484, 26484
.long 26480, 26480, 26480, 26480
.long 26476, 26476, 26476, 26476
.long 26472, 26472, 26472, 26472
.long 26468, 26468, 26468, 26468
.long 26464, 26464, 26464, 26464
.long 26460, 26460, 26460, 26460
.long 26456, 26456, 26456, 26456
.long 26452, 26452, 26452, 26452
.long 26448, 26448, 26448, 26448
.long 26444, 26444, 26444, 26444
.long 26440, 26440, 26440, 26440
.long 26436, 26436, 26436, 26436
.long 26432, 26432, 26432, 26432
.long 26428, 26428, 26428, 26428
.long 26424, 26424, 26424, 26424
.long 26420, 26420, 26420, 26420
.long 26416, 26416, 26416, 26416
.long 26412, 26412, 26412, 26412
.long 26408, 26408, 26408, 26408
.long 26404, 26404, 26404, 26404
.long 26400, 26400, 26400, 26400
.long 26396, 26396, 26396, 26396
.long 26392, 26392, 26392, 26392
.long 26388, 26388, 26388, 26388
.long 26384, 26384, 26384, 26384
.long 26380, 26380, 26380, 26380
.long 26376, 26376, 26376, 26376
.long 26372, 26372, 26372, 26372
.long 26368, 26368, 26368, 26368
.long 26364, 26364, 26364, 26364
.long 26360, 26360, 26360, 26360
.long 26356, 26356, 26356, 26356
.long 26352, 26352, 26352, 26352
.long 26348, 26348, 26348, 26348
.long 26344, 26344, 26344, 26344
.long 26340, 26340, 26340, 26340
.long 26336, 26336, 26336, 26336
.long 26332, 26332, 26332, 26332
.long 26328, 26328, 26328, 26328
.long 26324, 26324, 26324, 26324
.long 26320, 26320, 26320, 26320
.long 26316, 26316, 26316, 26316
.long 26312, 26312, 26312, 26312
.long 26308, 26308, 26308, 26308
.long 26304, 26304, 26304, 26304
.long 26300, 26300, 26300, 26300
.long 26296, 26296, 26296, 26296
.long 26292, 26292, 26292, 26292
.long 26288, 26288, 26288, 26288
.long 26284, 26284, 26284, 26284
.long 26280, 26280, 26280, 26280
.long 26276, 26276, 26276, 26276
.long 26272, 26272, 26272, 26272
.long 26268, 26268, 26268, 26268
.long 26264, 26264, 26264, 26264
.long 26260, 26260, 26260, 26260
.long 26256, 26256, 26256, 26256
.long 26252, 26252, 26252, 26252
.long 26248, 26248, 26248, 26248
.long 26244, 26244, 26244, 26244
.long 26240, 26240, 26240, 26240
.long 26236, 26236, 26236, 26236
.long 26232, 26232, 26232, 26232
.long 26228, 26228, 26228, 26228
.long 26224, 26224, 26224, 26224
.long 26220, 26220, 26220, 26220
.long 26216, 26216, 26216, 26216
.long 26212, 26212, 26212, 26212
.long 26208, 26208, 26208, 26208
.long 26204, 26204, 26204, 26204
.long 26200, 26200, 26200, 26200
.long 26196, 26196, 26196, 26196
.long 26192, 26192, 26192, 26192
.long 26188, 26188, 26188, 26188
.long 26184, 26184, 26184, 26184
.long 26180, 26180, 26180, 26180
.long 26176, 26176, 26176, 26176
.long 26172, 26172, 26172, 26172
.long 26168, 26168, 26168, 26168
.long 26164, 26164, 26164, 26164
.long 26160, 26160, 26160, 26160
.long 26156, 26156, 26156, 26156
.long 26152, 26152, 26152, 26152
.long 26148, 26148, 26148, 26148
.long 26144, 26144, 26144, 26144
.long 26140, 26140, 26140, 26140
.long 26136, 26136, 26136, 26136
.long 26132, 26132, 26132, 26132
.long 26128, 26128, 26128, 26128
.long 26124, 26124, 26124, 26124
.long 26120, 26120, 26120, 26120
.long 26116, 26116, 26116, 26116
.long 26112, 26112, 26112, 26112
.long 30460, 26108, 26108, 26108
.long 30456, 26104, 26104, 26104
.long 30452, 26100, 26100, 26100
.long 30448, 26096, 26096, 26096
.long 30444, 26092, 26092, 26092
.long 30440, 26088, 26088, 26088
.long 30436, 26084, 26084, 26084
.long 30432, 26080, 26080, 26080
.long 30428, 26076, 26076, 26076
.long 30424, 26072, 26072, 26072
.long 30420, 26068, 26068, 26068
.long 30416, 26064, 26064, 26064
.long 30412, 26060, 26060, 26060
.long 30408, 26056, 26056, 26056
.long 30404, 26052, 26052, 26052
.long 30400, 26048, 26048, 26048
.long 30396, 26044, 26044, 26044
.long 30392, 26040, 26040, 26040
.long 30388, 26036, 26036, 26036
.long 30384, 26032, 26032, 26032
.long 30380, 26028, 26028, 26028
.long 30376, 26024, 26024, 26024
.long 30372, 26020, 26020, 26020
.long 30368, 26016, 26016, 26016
.long 30364, 26012, 26012, 26012
.long 30360, 26008, 26008, 26008
.long 30356, 26004, 26004, 26004
.long 30352, 26000, 26000, 26000
.long 30348, 25996, 25996, 25996
.long 30344, 25992, 25992, 25992
.long 30340, 25988, 25988, 25988
.long 30336, 25984, 25984, 25984
.long 30332, 25980, 25980, 25980
.long 30328, 25976, 25976, 25976
.long 30324, 25972, 25972, 25972
.long 30320, 25968, 25968, 25968
.long 30316, 25964, 25964, 25964
.long 30312, 25960, 25960, 25960
.long 30308, 25956, 25956, 25956
.long 30304, 25952, 25952, 25952
.long 30300, 25948, 25948, 25948
.long 30296, 25944, 25944, 25944
.long 30292, 25940, 25940, 25940
.long 30288, 25936, 25936, 25936
.long 30284, 25932, 25932, 25932
.long 30280, 25928, 25928, 25928
.long 30276, 25924, 25924, 25924
.long 30272, 25920, 25920, 25920
.long 30268, 25916, 25916, 25916
.long 30264, 25912, 25912, 25912
.long 30260, 25908, 25908, 25908
.long 30256, 25904, 25904, 25904
.long 30252, 25900, 25900, 25900
.long 30248, 25896, 25896, 25896
.long 30244, 25892, 25892, 25892
.long 30240, 25888, 25888, 25888
.long 30236, 25884, 25884, 25884
.long 30232, 25880, 25880, 25880
.long 30228, 25876, 25876, 25876
.long 30224, 25872, 25872, 25872
.long 30220, 25868, 25868, 25868
.long 30216, 25864, 25864, 25864
.long 30212, 25860, 25860, 25860
.long 30208, 25856, 25856, 25856
.long 30204, 28028, 25852, 25852
.long 30200, 28024, 25848, 25848
.long 30196, 28020, 25844, 25844
.long 30192, 28016, 25840, 25840
.long 30188, 28012, 25836, 25836
.long 30184, 28008, 25832, 25832
.long 30180, 28004, 25828, 25828
.long 30176, 28000, 25824, 25824
.long 30172, 27996, 25820, 25820
.long 30168, 27992, 25816, 25816
.long 30164, 27988, 25812, 25812
.long 30160, 27984, 25808, 25808
.long 30156, 27980, 25804, 25804
.long 30152, 27976, 25800, 25800
.long 30148, 27972, 25796, 25796
.long 30144, 27968, 25792, 25792
.long 30140, 27964, 25788, 25788
.long 30136, 27960, 25784, 25784
.long 30132, 27956, 25780, 25780
.long 30128, 27952, 25776, 25776
.long 30124, 27948, 25772, 25772
.long 30120, 27944, 25768, 25768
.long 30116, 27940, 25764, 25764
.long 30112, 27936, 25760, 25760
.long 30108, 27932, 25756, 25756
.long 30104, 27928, 25752, 25752
.long 30100, 27924, 25748, 25748
.long 30096, 27920, 25744, 25744
.long 30092, 27916, 25740, 25740
.long 30088, 27912, 25736, 25736
.long 30084, 27908, 25732, 25732
.long 30080, 27904, 25728, 25728
.long 28988, 27900, 26812, 25724
.long 28984, 27896, 26808, 25720
.long 28980, 27892, 26804, 25716
.long 28976, 27888, 26800, 25712
.long 28972, 27884, 26796, 25708
.long 28968, 27880, 26792, 25704
.long 28964, 27876, 26788, 25700
.long 28960, 27872, 26784, 25696
.long 28956, 27868, 26780, 25692
.long 28952, 27864, 26776, 25688
.long 28948, 27860, 26772, 25684
.long 28944, 27856, 26768, 25680
.long 28940, 27852, 26764, 25676
.long 28936, 27848, 26760, 25672
.long 28932, 27844, 26756, 25668
.long 28928, 27840, 26752, 25664
.long 28924, 27836, 26748, 25660
.long 28920, 27832, 26744, 25656
.long 28916, 27828, 26740, 25652
.long 28912, 27824, 26736, 25648
.long 28908, 27820, 26732, 25644
.long 28904, 27816, 26728, 25640
.long 28900, 27812, 26724, 25636
.long 28896, 27808, 26720, 25632
.long 28892, 27804, 26716, 25628
.long 28888, 27800, 26712, 25624
.long 28884, 27796, 26708, 25620
.long 28880, 27792, 26704, 25616
.long 28876, 27788, 26700, 25612
.long 28872, 27784, 26696, 25608
.long 28868, 27780, 26692, 25604
.long 28864, 27776, 26688, 25600
.long 16896, 17984, 19072, 20160
.long 16900, 17988, 19076, 20164
.long 16904, 17992, 19080, 20168
.long 16908, 17996, 19084, 20172
.long 16912, 18000, 19088, 20176
.long 16916, 18004, 19092, 20180
.long 16920, 18008, 19096, 20184
.long 16924, 18012, 19100, 20188
.long 16928, 18016, 19104, 20192
.long 16932, 18020, 19108, 20196
.long 16936, 18024, 19112, 20200
.long 16940, 18028, 19116, 20204
.long 16944, 18032, 19120, 20208
.long 16948, 18036, 19124, 20212
.long 16952, 18040, 19128, 20216
.long 16956, 18044, 19132, 20220
.long 21248, 22336, 23424, 24512
.long 21252, 22340, 23428, 24516
.long 21256, 22344, 23432, 24520
.long 21260, 22348, 23436, 24524
.long 21264, 22352, 23440, 24528
.long 21268, 22356, 23444, 24532
.long 21272, 22360, 23448, 24536
.long 21276, 22364, 23452, 24540
.long 21280, 22368, 23456, 24544
.long 21284, 22372, 23460, 24548
.long 21288, 22376, 23464, 24552
.long 21292, 22380, 23468, 24556
.long 21296, 22384, 23472, 24560
.long 21300, 22388, 23476, 24564
.long 21304, 22392, 23480, 24568
.long 21308, 22396, 23484, 24572
.long 16960, 18048, 19136, 20224
.long 16964, 18052, 19140, 20228
.long 16968, 18056, 19144, 20232
.long 16972, 18060, 19148, 20236
.long 16976, 18064, 19152, 20240
.long 16980, 18068, 19156, 20244
.long 16984, 18072, 19160, 20248
.long 16988, 18076, 19164, 20252
.long 16992, 18080, 19168, 20256
.long 16996, 18084, 19172, 20260
.long 17000, 18088, 19176, 20264
.long 17004, 18092, 19180, 20268
.long 17008, 18096, 19184, 20272
.long 17012, 18100, 19188, 20276
.long 17016, 18104, 19192, 20280
.long 17020, 18108, 19196, 20284
.long 21312, 22400, 23488, 24576
.long 21316, 22404, 23492, 24580
.long 21320, 22408, 23496, 24584
.long 21324, 22412, 23500, 24588
.long 21328, 22416, 23504, 24592
.long 21332, 22420, 23508, 24596
.long 21336, 22424, 23512, 24600
.long 21340, 22428, 23516, 24604
.long 21344, 22432, 23520, 24608
.long 21348, 22436, 23524, 24612
.long 21352, 22440, 23528, 24616
.long 21356, 22444, 23532, 24620
.long 21360, 22448, 23536, 24624
.long 21364, 22452, 23540, 24628
.long 21368, 22456, 23544, 24632
.long 21372, 22460, 23548, 24636
.long 17152, 17216, 17280, 17344
.long 17156, 17220, 17284, 17348
.long 17160, 17224, 17288, 17352
.long 17164, 17228, 17292, 17356
.long 17168, 17232, 17296, 17360
.long 17172, 17236, 17300, 17364
.long 17176, 17240, 17304, 17368
.long 17180, 17244, 17308, 17372
.long 17184, 17248, 17312, 17376
.long 17188, 17252, 17316, 17380
.long 17192, 17256, 17320, 17384
.long 17196, 17260, 17324, 17388
.long 17200, 17264, 17328, 17392
.long 17204, 17268, 17332, 17396
.long 17208, 17272, 17336, 17400
.long 17212, 17276, 17340, 17404
.long 21504, 21568, 21632, 21696
.long 21508, 21572, 21636, 21700
.long 21512, 21576, 21640, 21704
.long 21516, 21580, 21644, 21708
.long 21520, 21584, 21648, 21712
.long 21524, 21588, 21652, 21716
.long 21528, 21592, 21656, 21720
.long 21532, 21596, 21660, 21724
.long 21536, 21600, 21664, 21728
.long 21540, 21604, 21668, 21732
.long 21544, 21608, 21672, 21736
.long 21548, 21612, 21676, 21740
.long 21552, 21616, 21680, 21744
.long 21556, 21620, 21684, 21748
.long 21560, 21624, 21688, 21752
.long 21564, 21628, 21692, 21756
.long 17408, 17472, 17536, 17600
.long 17412, 17476, 17540, 17604
.long 17416, 17480, 17544, 17608
.long 17420, 17484, 17548, 17612
.long 17424, 17488, 17552, 17616
.long 17428, 17492, 17556, 17620
.long 17432, 17496, 17560, 17624
.long 17436, 17500, 17564, 17628
.long 17440, 17504, 17568, 17632
.long 17444, 17508, 17572, 17636
.long 17448, 17512, 17576, 17640
.long 17452, 17516, 17580, 17644
.long 17456, 17520, 17584, 17648
.long 17460, 17524, 17588, 17652
.long 17464, 17528, 17592, 17656
.long 17468, 17532, 17596, 17660
.long 17664, 17728, 17792, 17856
.long 17668, 17732, 17796, 17860
.long 17672, 17736, 17800, 17864
.long 17676, 17740, 17804, 17868
.long 17680, 17744, 17808, 17872
.long 17684, 17748, 17812, 17876
.long 17688, 17752, 17816, 17880
.long 17692, 17756, 17820, 17884
.long 17696, 17760, 17824, 17888
.long 17700, 17764, 17828, 17892
.long 17704, 17768, 17832, 17896
.long 17708, 17772, 17836, 17900
.long 17712, 17776, 17840, 17904
.long 17716, 17780, 17844, 17908
.long 17720, 17784, 17848, 17912
.long 17724, 17788, 17852, 17916
.long 17024, 19200, 21376, 23552
.long 17028, 19204, 21380, 23556
.long 17032, 19208, 21384, 23560
.long 17036, 19212, 21388, 23564
.long 17040, 19216, 21392, 23568
.long 17044, 19220, 21396, 23572
.long 17048, 19224, 21400, 23576
.long 17052, 19228, 21404, 23580
.long 17056, 19232, 21408, 23584
.long 17060, 19236, 21412, 23588
.long 17064, 19240, 21416, 23592
.long 17068, 19244, 21420, 23596
.long 17072, 19248, 21424, 23600
.long 17076, 19252, 21428, 23604
.long 17080, 19256, 21432, 23608
.long 17084, 19260, 21436, 23612
.long 17088, 19264, 21440, 23616
.long 17092, 19268, 21444, 23620
.long 17096, 19272, 21448, 23624
.long 17100, 19276, 21452, 23628
.long 17104, 19280, 21456, 23632
.long 17108, 19284, 21460, 23636
.long 17112, 19288, 21464, 23640
.long 17116, 19292, 21468, 23644
.long 17120, 19296, 21472, 23648
.long 17124, 19300, 21476, 23652
.long 17128, 19304, 21480, 23656
.long 17132, 19308, 21484, 23660
.long 17136, 19312, 21488, 23664
.long 17140, 19316, 21492, 23668
.long 17144, 19320, 21496, 23672
.long 17148, 19324, 21500, 23676
.long 17920, 20096, 22272, 24448
.long 17924, 20100, 22276, 24452
.long 17928, 20104, 22280, 24456
.long 17932, 20108, 22284, 24460
.long 17936, 20112, 22288, 24464
.long 17940, 20116, 22292, 24468
.long 17944, 20120, 22296, 24472
.long 17948, 20124, 22300, 24476
.long 17952, 20128, 22304, 24480
.long 17956, 20132, 22308, 24484
.long 17960, 20136, 22312, 24488
.long 17964, 20140, 22316, 24492
.long 17968, 20144, 22320, 24496
.long 17972, 20148, 22324, 24500
.long 17976, 20152, 22328, 24504
.long 17980, 20156, 22332, 24508
.long 19008, 21184, 23360, 25536
.long 19012, 21188, 23364, 25540
.long 19016, 21192, 23368, 25544
.long 19020, 21196, 23372, 25548
.long 19024, 21200, 23376, 25552
.long 19028, 21204, 23380, 25556
.long 19032, 21208, 23384, 25560
.long 19036, 21212, 23388, 25564
.long 19040, 21216, 23392, 25568
.long 19044, 21220, 23396, 25572
.long 19048, 21224, 23400, 25576
.long 19052, 21228, 23404, 25580
.long 19056, 21232, 23408, 25584
.long 19060, 21236, 23412, 25588
.long 19064, 21240, 23416, 25592
.long 19068, 21244, 23420, 25596
.long 17024, 19200, 21376, 23552
.long 17028, 19204, 21380, 23556
.long 17032, 19208, 21384, 23560
.long 17036, 19212, 21388, 23564
.long 17040, 19216, 21392, 23568
.long 17044, 19220, 21396, 23572
.long 17048, 19224, 21400, 23576
.long 17052, 19228, 21404, 23580
.long 17056, 19232, 21408, 23584
.long 17060, 19236, 21412, 23588
.long 17064, 19240, 21416, 23592
.long 17068, 19244, 21420, 23596
.long 17072, 19248, 21424, 23600
.long 17076, 19252, 21428, 23604
.long 17080, 19256, 21432, 23608
.long 17084, 19260, 21436, 23612
.long 17088, 19264, 21440, 23616
.long 17092, 19268, 21444, 23620
.long 17096, 19272, 21448, 23624
.long 17100, 19276, 21452, 23628
.long 17104, 19280, 21456, 23632
.long 17108, 19284, 21460, 23636
.long 17112, 19288, 21464, 23640
.long 17116, 19292, 21468, 23644
.long 17120, 19296, 21472, 23648
.long 17124, 19300, 21476, 23652
.long 17128, 19304, 21480, 23656
.long 17132, 19308, 21484, 23660
.long 17136, 19312, 21488, 23664
.long 17140, 19316, 21492, 23668
.long 17144, 19320, 21496, 23672
.long 17148, 19324, 21500, 23676
.long 17920, 20096, 22272, 24448
.long 17924, 20100, 22276, 24452
.long 17928, 20104, 22280, 24456
.long 17932, 20108, 22284, 24460
.long 17936, 20112, 22288, 24464
.long 17940, 20116, 22292, 24468
.long 17944, 20120, 22296, 24472
.long 17948, 20124, 22300, 24476
.long 17952, 20128, 22304, 24480
.long 17956, 20132, 22308, 24484
.long 17960, 20136, 22312, 24488
.long 17964, 20140, 22316, 24492
.long 17968, 20144, 22320, 24496
.long 17972, 20148, 22324, 24500
.long 17976, 20152, 22328, 24504
.long 17980, 20156, 22332, 24508
.long 19008, 21184, 23360, 25536
.long 19012, 21188, 23364, 25540
.long 19016, 21192, 23368, 25544
.long 19020, 21196, 23372, 25548
.long 19024, 21200, 23376, 25552
.long 19028, 21204, 23380, 25556
.long 19032, 21208, 23384, 25560
.long 19036, 21212, 23388, 25564
.long 19040, 21216, 23392, 25568
.long 19044, 21220, 23396, 25572
.long 19048, 21224, 23400, 25576
.long 19052, 21228, 23404, 25580
.long 19056, 21232, 23408, 25584
.long 19060, 21236, 23412, 25588
.long 19064, 21240, 23416, 25592
.long 19068, 21244, 23420, 25596
.long 25600, 26688, 27776, 28864
.long 25604, 26692, 27780, 28868
.long 25608, 26696, 27784, 28872
.long 25612, 26700, 27788, 28876
.long 25616, 26704, 27792, 28880
.long 25620, 26708, 27796, 28884
.long 25624, 26712, 27800, 28888
.long 25628, 26716, 27804, 28892
.long 25632, 26720, 27808, 28896
.long 25636, 26724, 27812, 28900
.long 25640, 26728, 27816, 28904
.long 25644, 26732, 27820, 28908
.long 25648, 26736, 27824, 28912
.long 25652, 26740, 27828, 28916
.long 25656, 26744, 27832, 28920
.long 25660, 26748, 27836, 28924
.long 29952, 31040, 32128, 33216
.long 29956, 31044, 32132, 33220
.long 29960, 31048, 32136, 33224
.long 29964, 31052, 32140, 33228
.long 29968, 31056, 32144, 33232
.long 29972, 31060, 32148, 33236
.long 29976, 31064, 32152, 33240
.long 29980, 31068, 32156, 33244
.long 29984, 31072, 32160, 33248
.long 29988, 31076, 32164, 33252
.long 29992, 31080, 32168, 33256
.long 29996, 31084, 32172, 33260
.long 30000, 31088, 32176, 33264
.long 30004, 31092, 32180, 33268
.long 30008, 31096, 32184, 33272
.long 30012, 31100, 32188, 33276
.long 25664, 26752, 27840, 28928
.long 25668, 26756, 27844, 28932
.long 25672, 26760, 27848, 28936
.long 25676, 26764, 27852, 28940
.long 25680, 26768, 27856, 28944
.long 25684, 26772, 27860, 28948
.long 25688, 26776, 27864, 28952
.long 25692, 26780, 27868, 28956
.long 25696, 26784, 27872, 28960
.long 25700, 26788, 27876, 28964
.long 25704, 26792, 27880, 28968
.long 25708, 26796, 27884, 28972
.long 25712, 26800, 27888, 28976
.long 25716, 26804, 27892, 28980
.long 25720, 26808, 27896, 28984
.long 25724, 26812, 27900, 28988
.long 30016, 31104, 32192, 33280
.long 30020, 31108, 32196, 33284
.long 30024, 31112, 32200, 33288
.long 30028, 31116, 32204, 33292
.long 30032, 31120, 32208, 33296
.long 30036, 31124, 32212, 33300
.long 30040, 31128, 32216, 33304
.long 30044, 31132, 32220, 33308
.long 30048, 31136, 32224, 33312
.long 30052, 31140, 32228, 33316
.long 30056, 31144, 32232, 33320
.long 30060, 31148, 32236, 33324
.long 30064, 31152, 32240, 33328
.long 30068, 31156, 32244, 33332
.long 30072, 31160, 32248, 33336
.long 30076, 31164, 32252, 33340
.long 25856, 25920, 25984, 26048
.long 25860, 25924, 25988, 26052
.long 25864, 25928, 25992, 26056
.long 25868, 25932, 25996, 26060
.long 25872, 25936, 26000, 26064
.long 25876, 25940, 26004, 26068
.long 25880, 25944, 26008, 26072
.long 25884, 25948, 26012, 26076
.long 25888, 25952, 26016, 26080
.long 25892, 25956, 26020, 26084
.long 25896, 25960, 26024, 26088
.long 25900, 25964, 26028, 26092
.long 25904, 25968, 26032, 26096
.long 25908, 25972, 26036, 26100
.long 25912, 25976, 26040, 26104
.long 25916, 25980, 26044, 26108
.long 30208, 30272, 30336, 30400
.long 30212, 30276, 30340, 30404
.long 30216, 30280, 30344, 30408
.long 30220, 30284, 30348, 30412
.long 30224, 30288, 30352, 30416
.long 30228, 30292, 30356, 30420
.long 30232, 30296, 30360, 30424
.long 30236, 30300, 30364, 30428
.long 30240, 30304, 30368, 30432
.long 30244, 30308, 30372, 30436
.long 30248, 30312, 30376, 30440
.long 30252, 30316, 30380, 30444
.long 30256, 30320, 30384, 30448
.long 30260, 30324, 30388, 30452
.long 30264, 30328, 30392, 30456
.long 30268, 30332, 30396, 30460
.long 26112, 26176, 26240, 26304
.long 26116, 26180, 26244, 26308
.long 26120, 26184, 26248, 26312
.long 26124, 26188, 26252, 26316
.long 26128, 26192, 26256, 26320
.long 26132, 26196, 26260, 26324
.long 26136, 26200, 26264, 26328
.long 26140, 26204, 26268, 26332
.long 26144, 26208, 26272, 26336
.long 26148, 26212, 26276, 26340
.long 26152, 26216, 26280, 26344
.long 26156, 26220, 26284, 26348
.long 26160, 26224, 26288, 26352
.long 26164, 26228, 26292, 26356
.long 26168, 26232, 26296, 26360
.long 26172, 26236, 26300, 26364
.long 26368, 26432, 26496, 26560
.long 26372, 26436, 26500, 26564
.long 26376, 26440, 26504, 26568
.long 26380, 26444, 26508, 26572
.long 26384, 26448, 26512, 26576
.long 26388, 26452, 26516, 26580
.long 26392, 26456, 26520, 26584
.long 26396, 26460, 26524, 26588
.long 26400, 26464, 26528, 26592
.long 26404, 26468, 26532, 26596
.long 26408, 26472, 26536, 26600
.long 26412, 26476, 26540, 26604
.long 26416, 26480, 26544, 26608
.long 26420, 26484, 26548, 26612
.long 26424, 26488, 26552, 26616
.long 26428, 26492, 26556, 26620
.long 25728, 27904, 30080, 32256
.long 25732, 27908, 30084, 32260
.long 25736, 27912, 30088, 32264
.long 25740, 27916, 30092, 32268
.long 25744, 27920, 30096, 32272
.long 25748, 27924, 30100, 32276
.long 25752, 27928, 30104, 32280
.long 25756, 27932, 30108, 32284
.long 25760, 27936, 30112, 32288
.long 25764, 27940, 30116, 32292
.long 25768, 27944, 30120, 32296
.long 25772, 27948, 30124, 32300
.long 25776, 27952, 30128, 32304
.long 25780, 27956, 30132, 32308
.long 25784, 27960, 30136, 32312
.long 25788, 27964, 30140, 32316
.long 25792, 27968, 30144, 32320
.long 25796, 27972, 30148, 32324
.long 25800, 27976, 30152, 32328
.long 25804, 27980, 30156, 32332
.long 25808, 27984, 30160, 32336
.long 25812, 27988, 30164, 32340
.long 25816, 27992, 30168, 32344
.long 25820, 27996, 30172, 32348
.long 25824, 28000, 30176, 32352
.long 25828, 28004, 30180, 32356
.long 25832, 28008, 30184, 32360
.long 25836, 28012, 30188, 32364
.long 25840, 28016, 30192, 32368
.long 25844, 28020, 30196, 32372
.long 25848, 28024, 30200, 32376
.long 25852, 28028, 30204, 32380
.long 26624, 28800, 30976, 33152
.long 26628, 28804, 30980, 33156
.long 26632, 28808, 30984, 33160
.long 26636, 28812, 30988, 33164
.long 26640, 28816, 30992, 33168
.long 26644, 28820, 30996, 33172
.long 26648, 28824, 31000, 33176
.long 26652, 28828, 31004, 33180
.long 26656, 28832, 31008, 33184
.long 26660, 28836, 31012, 33188
.long 26664, 28840, 31016, 33192
.long 26668, 28844, 31020, 33196
.long 26672, 28848, 31024, 33200
.long 26676, 28852, 31028, 33204
.long 26680, 28856, 31032, 33208
.long 26684, 28860, 31036, 33212
.long 27712, 29888, 32064, 34240
.long 27716, 29892, 32068, 34244
.long 27720, 29896, 32072, 34248
.long 27724, 29900, 32076, 34252
.long 27728, 29904, 32080, 34256
.long 27732, 29908, 32084, 34260
.long 27736, 29912, 32088, 34264
.long 27740, 29916, 32092, 34268
.long 27744, 29920, 32096, 34272
.long 27748, 29924, 32100, 34276
.long 27752, 29928, 32104, 34280
.long 27756, 29932, 32108, 34284
.long 27760, 29936, 32112, 34288
.long 27764, 29940, 32116, 34292
.long 27768, 29944, 32120, 34296
.long 27772, 29948, 32124, 34300
.long 25728, 27904, 30080, 32256
.long 25732, 27908, 30084, 32260
.long 25736, 27912, 30088, 32264
.long 25740, 27916, 30092, 32268
.long 25744, 27920, 30096, 32272
.long 25748, 27924, 30100, 32276
.long 25752, 27928, 30104, 32280
.long 25756, 27932, 30108, 32284
.long 25760, 27936, 30112, 32288
.long 25764, 27940, 30116, 32292
.long 25768, 27944, 30120, 32296
.long 25772, 27948, 30124, 32300
.long 25776, 27952, 30128, 32304
.long 25780, 27956, 30132, 32308
.long 25784, 27960, 30136, 32312
.long 25788, 27964, 30140, 32316
.long 25792, 27968, 30144, 32320
.long 25796, 27972, 30148, 32324
.long 25800, 27976, 30152, 32328
.long 25804, 27980, 30156, 32332
.long 25808, 27984, 30160, 32336
.long 25812, 27988, 30164, 32340
.long 25816, 27992, 30168, 32344
.long 25820, 27996, 30172, 32348
.long 25824, 28000, 30176, 32352
.long 25828, 28004, 30180, 32356
.long 25832, 28008, 30184, 32360
.long 25836, 28012, 30188, 32364
.long 25840, 28016, 30192, 32368
.long 25844, 28020, 30196, 32372
.long 25848, 28024, 30200, 32376
.long 25852, 28028, 30204, 32380
.long 26624, 28800, 30976, 33152
.long 26628, 28804, 30980, 33156
.long 26632, 28808, 30984, 33160
.long 26636, 28812, 30988, 33164
.long 26640, 28816, 30992, 33168
.long 26644, 28820, 30996, 33172
.long 26648, 28824, 31000, 33176
.long 26652, 28828, 31004, 33180
.long 26656, 28832, 31008, 33184
.long 26660, 28836, 31012, 33188
.long 26664, 28840, 31016, 33192
.long 26668, 28844, 31020, 33196
.long 26672, 28848, 31024, 33200
.long 26676, 28852, 31028, 33204
.long 26680, 28856, 31032, 33208
.long 26684, 28860, 31036, 33212
.long 27712, 29888, 32064, 34240
.long 27716, 29892, 32068, 34244
.long 27720, 29896, 32072, 34248
.long 27724, 29900, 32076, 34252
.long 27728, 29904, 32080, 34256
.long 27732, 29908, 32084, 34260
.long 27736, 29912, 32088, 34264
.long 27740, 29916, 32092, 34268
.long 27744, 29920, 32096, 34272
.long 27748, 29924, 32100, 34276
.long 27752, 29928, 32104, 34280
.long 27756, 29932, 32108, 34284
.long 27760, 29936, 32112, 34288
.long 27764, 29940, 32116, 34292
.long 27768, 29944, 32120, 34296
.long 27772, 29948, 32124, 34300
.size KG_TABLE, 24576
TABLE_END:
.section .rodata,"a"
.p2align 6
.amdhsa_kernel sequential_preLN__ssm_conv_s4__glu_gated_reglu__prompt_kernel
  .amdhsa_next_free_vgpr 256
  .amdhsa_next_free_sgpr 100
  .amdhsa_accum_offset 256
  .amdhsa_group_segment_fixed_size 0
  .amdhsa_kernarg_size 128
  .amdhsa_user_sgpr_count 2
  .amdhsa_user_sgpr_kernarg_segment_ptr 1
  .amdhsa_system_sgpr_workgroup_id_x 1
.end_amdhsa_kernel
```
